```python
import torch

def _softmax(x, axis=-1):
    return torch.softmax(x, dim=axis)
def _gelu(x):
    return torch.nn.functional.gelu(x, approximate="tanh")
def _silu(x):
    return torch.nn.functional.silu(x)
def _sigmoid(x):
    return torch.sigmoid(x)
def _layernorm(x, axis=-1, eps=1e-5):
    m = x.mean(dim=axis, keepdim=True)
    v = x.var(dim=axis, keepdim=True, unbiased=False)
    return (x - m) / torch.sqrt(v + eps)
def _scatter_add(tgt, idx, src, axis=0):
    return tgt.clone().index_add_(axis, idx, src)
def _segment_sum(src, seg, n):
    out = torch.zeros((n,) + src.shape[1:], dtype=src.dtype)
    return out.index_add_(0, seg, src)
def _pad(x, pw):
    flat = tuple(v for pair in reversed(pw) for v in pair)
    return torch.nn.functional.pad(x, flat)

kernel_name = 'gated_mix__ssm_conv_s5__glu_gated_geglu__prompt'

def setup_inputs():

    _w = (lambda a: (lambda t: t.to(torch.bfloat16) if t.is_floating_point() else t)(torch.as_tensor(a)))
    def _A_setup():
        B, S, D = 1, 2048, 512
        P = D
        Lambda_re = -0.5 * (lambda _x: torch.exp(torch.as_tensor(_x)))((lambda *s: torch.randn(*s, dtype=torch.bfloat16) * 0.2)(P))
        Lambda_im = (lambda *s: torch.randn(*s, dtype=torch.bfloat16) * 0.4)(P) * 1.0
        B_re = (lambda *s: torch.randn(*s, dtype=torch.bfloat16) * 0.2)(P, D) * (D ** -0.5)
        B_im = (lambda *s: torch.randn(*s, dtype=torch.bfloat16) * 0.2)(P, D) * (D ** -0.5)
        C_re = (lambda *s: torch.randn(*s, dtype=torch.bfloat16) * 0.2)(D, P) * (P ** -0.5)
        C_im = (lambda *s: torch.randn(*s, dtype=torch.bfloat16) * 0.2)(D, P) * (P ** -0.5)
        log_dt = (lambda *s: torch.randn(*s, dtype=torch.bfloat16) * 0.2)(P) * 0.3 - 2.0
        Dskip = (lambda *s: torch.randn(*s, dtype=torch.bfloat16) * 0.05)(D)
        return {
            "x": _w((lambda *s: torch.randn(*s, dtype=torch.bfloat16) * 0.05)(B, S, D)),
            "Lambda_re": _w(Lambda_re),
            "Lambda_im": _w(Lambda_im),
            "B_re": _w(B_re),
            "B_im": _w(B_im),
            "C_re": _w(C_re),
            "C_im": _w(C_im),
            "log_dt": _w(log_dt),
            "Dskip": _w(Dskip),
        }
    _A_in = _A_setup()

    def _B_setup():
        B, S, Dm, Df = 1, 2048, 512, 1792
        return {
            "x": _w((lambda *s: torch.randn(*s, dtype=torch.bfloat16) * 0.05)(B, S, Dm)),
            "w_gate": _w((lambda *s: torch.randn(*s, dtype=torch.bfloat16) * 1.6)(Dm, Df) * (Dm ** -0.5)),
            "w_up": _w((lambda *s: torch.randn(*s, dtype=torch.bfloat16) * 1.6)(Dm, Df) * (Dm ** -0.5)),
            "w_down": _w((lambda *s: torch.randn(*s, dtype=torch.bfloat16) * 1.6)(Df, Dm) * (Df ** -0.5)),
        }
    _B_in = _B_setup()

    return {
        "A_x": _A_in["x"],
        "A_Lambda_re": _A_in["Lambda_re"],
        "A_Lambda_im": _A_in["Lambda_im"],
        "A_B_re": _A_in["B_re"],
        "A_B_im": _A_in["B_im"],
        "A_C_re": _A_in["C_re"],
        "A_C_im": _A_in["C_im"],
        "A_log_dt": _A_in["log_dt"],
        "A_Dskip": _A_in["Dskip"],
        "B_x": _B_in["x"],
        "B_w_gate": _B_in["w_gate"],
        "B_w_up": _B_in["w_up"],
        "B_w_down": _B_in["w_down"],
        "gate_w": _w((lambda *s: torch.randn(*s, dtype=torch.bfloat16) * 0.05)(512) * 16.0),
    }

def reference(A_x, A_Lambda_re, A_Lambda_im, A_B_re, A_B_im, A_C_re, A_C_im, A_log_dt, A_Dskip, B_x, B_w_gate, B_w_up, B_w_down, gate_w):
    def _A_ref(x, Lambda_re, Lambda_im, B_re, B_im, C_re, C_im, log_dt, Dskip):
        Bsz, L, H = x.shape
        Lam = Lambda_re + 1j * Lambda_im
        Bmat = B_re + 1j * B_im
        Cmat = C_re + 1j * C_im
        dt = torch.exp(log_dt)
        Lam_bar = torch.exp(dt * Lam)
        B_bar = ((Lam_bar - 1.0) / Lam)[:, None] * Bmat
        Bu = torch.einsum("bld,pd->blp", x + 0j, B_bar)
        h = torch.zeros_like(Bu[:, 0, :])
        hs = []
        for t in range(L):
            h = Lam_bar[None, :] * h + Bu[:, t, :]
            hs.append(h)
        hseq = torch.stack(hs, 1)
        y = 2.0 * torch.einsum("blp,dp->bld", hseq, Cmat).real + x * Dskip[None, None, :]
        return y

    def _B_ref(x, w_gate, w_up, w_down):
        g = torch.einsum("bsd,df->bsf", x, w_gate)
        u = torch.einsum("bsd,df->bsf", x, w_up)
        h = _gelu(g) * u
        return torch.einsum("bsf,fd->bsd", h, w_down)

    x = A_x
    g = _sigmoid((x * gate_w).sum(-1, keepdims=True))
    a = _A_ref(x, A_Lambda_re, A_Lambda_im, A_B_re, A_B_im, A_C_re, A_C_im, A_log_dt, A_Dskip)
    b = _B_ref(x, B_w_gate, B_w_up, B_w_down)
    return g * a + (1 - g) * b
```

```asm
; @launch grid=(256,1,1) block=(256,1,1) lds=163840
.amdgcn_target "amdgcn-amd-amdhsa--gfx950"
.text
.globl gated_mix__ssm_conv_s5__glu_gated_geglu__prompt_kernel
.p2align 8
.type gated_mix__ssm_conv_s5__glu_gated_geglu__prompt_kernel,@function
gated_mix__ssm_conv_s5__glu_gated_geglu__prompt_kernel:
    s_cmp_ge_u32 s2, 256
    s_cbranch_scc1 L_exit
    s_getpc_b64 s[68:69]
L_pc:
    s_bfe_u32 s3, s2, 0x30003
    v_lshlrev_b32 v25, 4, v0
    s_lshl_b32 s3, s3, 12
    s_mov_b32 s70, L_codeend-L_pc
    s_mov_b32 s71, 0x20000
    buffer_load_dwordx4 a[252:255], v25, s[68:71], s3 offen
    s_load_dwordx16 s[4:19], s[0:1], 0
    s_load_dwordx16 s[20:35], s[0:1], 64
    s_load_dwordx2 s[36:37], s[0:1], 128
    v_and_b32 v1, 63, v0
    v_lshrrev_b32 v25, 6, v0
    s_lshr_b32 s38, s2, 4
    s_and_b32 s39, s2, 15
    v_readfirstlane_b32 s40, v25
    v_lshrrev_b32 v25, 5, v1
    v_lshlrev_b32 v25, 4, v25
    v_bfe_u32 v26, v1, 3, 1
    v_lshl_add_u32 v25, v26, 3, v25
    v_bfe_u32 v26, v1, 4, 1
    v_add_u32 v25, v25, v26
    v_lshlrev_b32 v25, 10, v25
    v_and_b32 v26, 7, v1
    v_lshrrev_b32 v27, 4, v1
    v_xor_b32 v28, v26, v27
    v_xor_b32 v29, 4, v28
    v_lshlrev_b32 v28, 4, v28
    v_lshlrev_b32 v29, 4, v29
    v_add_u32 v2, v25, v28
    v_add_u32 v3, v25, v29
    v_add_u32 v3, 1024, v3
    v_add_u32 v4, v25, v28
    v_add_u32 v4, 2048, v4
    v_add_u32 v5, v25, v29
    v_add_u32 v5, 3072, v5
    v_lshrrev_b32 v25, 3, v1
    v_lshlrev_b32 v25, 10, v25
    v_add_u32 v6, v25, v28
    v_add_u32 v7, v25, v29
    v_add_u32 v7, 7168, v7
    s_lshl_b32 s81, s40, 12
    s_add_u32 s78, s81, 119552
    s_lshl_b32 s82, s38, 2
    s_add_u32 s82, s82, s40
    s_lshl_b32 s75, s82, 15
    s_and_b32 s82, s40, 1
    s_lshr_b32 s83, s40, 1
    s_lshl_b32 s84, s39, 1
    s_add_u32 s84, s84, s82
    s_lshl_b32 s76, s84, 14
    s_lshl_b32 s79, s83, 12
    s_lshl_b32 s84, s82, 11
    s_add_u32 s79, s79, s84
    s_add_u32 s79, s79, 86784
    s_mul_i32 s77, s82, 114688
    s_mul_i32 s84, s39, 224
    s_add_u32 s77, s77, s84
    s_mul_i32 s80, s83, 14464
    s_mul_i32 s84, s82, 7168
    s_add_u32 s80, s80, s84
    s_waitcnt lgkmcnt(0)
    s_mov_b32 s44, s4
    s_mov_b32 s45, s5
    s_mov_b32 s46, 2097152
    s_mov_b32 s47, 0x20000
    s_cmp_eq_u32 s83, 0
    s_cselect_b32 s48, s10, s12
    s_cselect_b32 s49, s11, s13
    s_mov_b32 s50, 524288
    s_mov_b32 s51, 0x20000
    s_cselect_b32 s52, s24, s26
    s_cselect_b32 s53, s25, s27
    s_mov_b32 s54, 1835008
    s_mov_b32 s55, 0x20000
    s_add_u32 m0, s78, 0
    s_add_u32 s72, s75, 0
    buffer_load_dwordx4 v2, s[44:47], s72 offen offset:0  lds
    buffer_load_dwordx4 v3, s[44:47], s72 offen offset:1024  lds
    buffer_load_dwordx4 v4, s[44:47], s72 offen offset:2048  lds
    buffer_load_dwordx4 v5, s[44:47], s72 offen offset:3072  lds
    s_add_u32 m0, s79, 0
    s_add_u32 s73, s76, 0
    buffer_load_dwordx4 v6, s[48:51], s73 offen offset:0  lds
    buffer_load_dwordx4 v7, s[48:51], s73 offen offset:1024  lds
    s_mov_b32 s64, s30
    s_mov_b32 s65, s31
    s_mov_b32 s66, 1024
    s_mov_b32 s67, 0x20000
    v_lshlrev_b32 v22, 4, v1
    s_lshl_b32 s81, s38, 7
    s_lshl_b32 s82, s39, 3
    s_add_u32 s81, s81, s82
    s_lshl_b32 s82, s40, 1
    s_add_u32 s85, s81, s82
    s_lshl_b32 s81, s85, 10
    buffer_load_dwordx4 v[232:235], v22, s[44:47], s81 offen
    buffer_load_dwordx4 v[236:239], v22, s[44:47], s81 offen offset:1024
    buffer_load_dwordx4 v[240:243], v22, s[64:67], 0 offen
    v_and_b32 v25, 31, v1
    s_lshl_b32 s82, s39, 6
    v_lshlrev_b32 v25, 1, v25
    v_add_u32 v25, s82, v25
    s_mov_b32 s68, s6
    s_mov_b32 s69, s7
    s_mov_b32 s70, 1024
    s_mov_b32 s71, 0x20000
    buffer_load_ushort v244, v25, s[68:71], 0 offen
    s_mov_b32 s68, s8
    s_mov_b32 s69, s9
    s_mov_b32 s70, 1024
    s_mov_b32 s71, 0x20000
    buffer_load_ushort v245, v25, s[68:71], 0 offen
    s_mov_b32 s68, s18
    s_mov_b32 s69, s19
    s_mov_b32 s70, 1024
    s_mov_b32 s71, 0x20000
    buffer_load_ushort v246, v25, s[68:71], 0 offen
    s_add_u32 m0, s78, 16384
    s_add_u32 s72, s75, 128
    buffer_load_dwordx4 v2, s[44:47], s72 offen offset:0  lds
    buffer_load_dwordx4 v3, s[44:47], s72 offen offset:1024  lds
    buffer_load_dwordx4 v4, s[44:47], s72 offen offset:2048  lds
    buffer_load_dwordx4 v5, s[44:47], s72 offen offset:3072  lds
    s_add_u32 m0, s79, 8192
    s_add_u32 s73, s76, 128
    buffer_load_dwordx4 v6, s[48:51], s73 offen offset:0  lds
    buffer_load_dwordx4 v7, s[48:51], s73 offen offset:1024  lds
    s_mov_b32 s81, 4682
    s_mov_b32 s82, 3584
    v_add_u32 v25, 0, v1
    v_mul_lo_u32 v26, v25, s81
    v_lshrrev_b32 v26, 16, v26
    v_mul_u32_u24 v27, 14, v26
    v_sub_u32 v27, v25, v27
    v_lshlrev_b32 v27, 4, v27
    v_mul_lo_u32 v26, v26, s82
    v_add_u32 v8, v26, v27
    v_add_u32 v25, 64, v1
    v_mul_lo_u32 v26, v25, s81
    v_lshrrev_b32 v26, 16, v26
    v_mul_u32_u24 v27, 14, v26
    v_sub_u32 v27, v25, v27
    v_lshlrev_b32 v27, 4, v27
    v_mul_lo_u32 v26, v26, s82
    v_add_u32 v9, v26, v27
    v_subrev_u32 v9, 1024, v9
    v_add_u32 v25, 128, v1
    v_mul_lo_u32 v26, v25, s81
    v_lshrrev_b32 v26, 16, v26
    v_mul_u32_u24 v27, 14, v26
    v_sub_u32 v27, v25, v27
    v_lshlrev_b32 v27, 4, v27
    v_mul_lo_u32 v26, v26, s82
    v_add_u32 v10, v26, v27
    v_subrev_u32 v10, 2048, v10
    v_add_u32 v25, 192, v1
    v_mul_lo_u32 v26, v25, s81
    v_lshrrev_b32 v26, 16, v26
    v_mul_u32_u24 v27, 14, v26
    v_sub_u32 v27, v25, v27
    v_lshlrev_b32 v27, 4, v27
    v_mul_lo_u32 v26, v26, s82
    v_add_u32 v11, v26, v27
    v_subrev_u32 v11, 3072, v11
    v_add_u32 v25, 256, v1
    v_mul_lo_u32 v26, v25, s81
    v_lshrrev_b32 v26, 16, v26
    v_mul_u32_u24 v27, 14, v26
    v_sub_u32 v27, v25, v27
    v_lshlrev_b32 v27, 4, v27
    v_mul_lo_u32 v26, v26, s82
    v_add_u32 v12, v26, v27
    v_add_u32 v25, 320, v1
    v_mul_lo_u32 v26, v25, s81
    v_lshrrev_b32 v26, 16, v26
    v_mul_u32_u24 v27, 14, v26
    v_sub_u32 v27, v25, v27
    v_lshlrev_b32 v27, 4, v27
    v_mul_lo_u32 v26, v26, s82
    v_add_u32 v13, v26, v27
    v_subrev_u32 v13, 1024, v13
    v_add_u32 v25, 384, v1
    v_mul_lo_u32 v26, v25, s81
    v_lshrrev_b32 v26, 16, v26
    v_mul_u32_u24 v27, 14, v26
    v_sub_u32 v27, v25, v27
    v_lshlrev_b32 v27, 4, v27
    v_mul_lo_u32 v26, v26, s82
    v_add_u32 v14, v26, v27
    v_subrev_u32 v14, 2048, v14
    v_lshrrev_b32 v25, 5, v1
    v_lshlrev_b32 v25, 3, v25
    v_bfe_u32 v26, v1, 2, 2
    v_add_u32 v25, v25, v26
    v_mul_u32_u24 v25, 224, v25
    v_bfe_u32 v26, v1, 1, 1
    v_mul_u32_u24 v26, 14464, v26
    v_add_u32 v25, v25, v26
    v_bfe_u32 v26, v1, 4, 1
    v_lshlrev_b32 v26, 4, v26
    v_add_u32 v25, v25, v26
    v_and_b32 v26, 1, v1
    v_lshlrev_b32 v26, 3, v26
    v_add_u32 v15, v25, v26
    v_add_u32 v16, 57856, v15
    v_and_b32 v25, 31, v1
    v_lshlrev_b32 v26, 7, v25
    v_bfe_u32 v27, v1, 1, 3
    v_lshrrev_b32 v28, 5, v1
    v_xor_b32 v27, v27, v28
    s_lshl_b32 s81, s40, 12
    s_add_u32 s81, s81, 119552
    v_xor_b32 v28, 0, v27
    v_lshlrev_b32 v28, 4, v28
    v_add_u32 v28, v26, v28
    v_add_u32 v17, 86784, v28
    v_add_u32 v21, s81, v28
    v_xor_b32 v28, 2, v27
    v_lshlrev_b32 v28, 4, v28
    v_add_u32 v28, v26, v28
    v_add_u32 v18, 86784, v28
    v_add_u32 v22, s81, v28
    v_xor_b32 v28, 4, v27
    v_lshlrev_b32 v28, 4, v28
    v_add_u32 v28, v26, v28
    v_add_u32 v19, 86784, v28
    v_add_u32 v23, s81, v28
    v_xor_b32 v28, 6, v27
    v_lshlrev_b32 v28, 4, v28
    v_add_u32 v28, v26, v28
    v_add_u32 v20, 86784, v28
    v_add_u32 v24, s81, v28
    s_mov_b32 s56, s36
    s_mov_b32 s57, s37
    s_mov_b32 s58, 67108864
    s_mov_b32 s59, 0x20000
    s_mov_b32 s60, s34
    s_mov_b32 s61, s35
    s_mov_b32 s62, 256
    s_mov_b32 s63, 0x20000
    s_lshr_b32 s81, s2, 6
    s_lshl_b32 s81, s81, 2
    s_bfe_u32 s82, s2, 0x20001
    s_add_u32 s41, s81, s82
    s_and_b32 s42, s2, 1
    s_bfe_u32 s43, s2, 0x30003
    s_mul_i32 s92, s40, 40960
    v_lshrrev_b32 v32, 3, v1
    v_lshlrev_b32 v32, 10, v32
    v_bfe_u32 v33, v1, 4, 1
    v_lshlrev_b32 v33, 2, v33
    v_and_b32 v34, 7, v1
    v_xor_b32 v33, v33, v34
    v_lshl_add_u32 v35, v33, 4, v32
    v_accvgpr_write_b32 a176, v35
    v_add_u32 v35, 7168, v35
    v_accvgpr_write_b32 a177, v35
    v_lshrrev_b32 v33, 4, v1
    v_xor_b32 v33, v33, v34
    v_xor_b32 v34, 4, v33
    v_lshlrev_b32 v33, 4, v33
    v_lshlrev_b32 v34, 4, v34
    v_add_u32 v35, v32, v33
    v_accvgpr_write_b32 a178, v35
    v_add_u32 v35, v32, v34
    v_add_u32 v35, 7168, v35
    v_accvgpr_write_b32 a179, v35
    v_add_u32 v35, v32, v33
    v_add_u32 v35, 14336, v35
    v_accvgpr_write_b32 a180, v35
    v_add_u32 v35, v32, v34
    v_add_u32 v35, 21504, v35
    v_accvgpr_write_b32 a181, v35
    v_lshrrev_b32 v32, 5, v1
    v_lshlrev_b32 v32, 2, v32
    v_bfe_u32 v33, v1, 2, 2
    v_add_u32 v32, v32, v33
    v_lshlrev_b32 v32, 7, v32
    v_bfe_u32 v33, v1, 4, 1
    v_lshl_add_u32 v32, v33, 5, v32
    v_and_b32 v33, 3, v1
    v_lshl_add_u32 v32, v33, 3, v32
    v_add_u32 v32, s92, v32
    v_bfe_u32 v33, v1, 3, 1
    v_lshlrev_b32 v33, 6, v33
    s_and_b32 s83, s40, 1
    s_lshl_b32 s83, s83, 6
    v_xor_b32 v33, s83, v33
    v_add_u32 v35, v32, v33
    v_accvgpr_write_b32 a182, v35
    v_xor_b32 v33, 64, v33
    v_add_u32 v35, v32, v33
    v_accvgpr_write_b32 a183, v35
    v_and_b32 v32, 31, v1
    v_lshlrev_b32 v32, 7, v32
    v_add_u32 v32, s92, v32
    v_bfe_u32 v33, v1, 1, 3
    v_lshrrev_b32 v34, 5, v1
    v_xor_b32 v33, v33, v34
    v_xor_b32 v34, 0, v33
    v_lshl_add_u32 v35, v34, 4, v32
    v_accvgpr_write_b32 a184, v35
    v_xor_b32 v34, 2, v33
    v_lshl_add_u32 v35, v34, 4, v32
    v_accvgpr_write_b32 a185, v35
    v_xor_b32 v34, 4, v33
    v_lshl_add_u32 v35, v34, 4, v32
    v_accvgpr_write_b32 a186, v35
    v_xor_b32 v34, 6, v33
    v_lshl_add_u32 v35, v34, 4, v32
    v_accvgpr_write_b32 a187, v35
    s_add_u32 s83, s92, 36864
    v_and_b32 v32, 31, v1
    v_lshlrev_b32 v32, 6, v32
    v_add_u32 v32, s83, v32
    v_bfe_u32 v33, v1, 1, 2
    v_lshrrev_b32 v34, 5, v1
    v_lshlrev_b32 v34, 1, v34
    v_xor_b32 v34, v34, v33
    v_lshl_add_u32 v35, v34, 4, v32
    v_accvgpr_write_b32 a188, v35
    v_xor_b32 v34, 1, v34
    v_lshl_add_u32 v35, v34, 4, v32
    v_accvgpr_write_b32 a189, v35
    v_lshrrev_b32 v32, 5, v1
    v_lshlrev_b32 v32, 3, v32
    v_bfe_u32 v33, v1, 2, 2
    v_add_u32 v32, v32, v33
    v_lshlrev_b32 v32, 6, v32
    v_and_b32 v33, 1, v1
    v_lshlrev_b32 v33, 1, v33
    v_bfe_u32 v34, v1, 4, 1
    v_add_u32 v33, v33, v34
    v_bfe_u32 v34, v1, 3, 1
    v_xor_b32 v33, v33, v34
    v_bfe_u32 v34, v1, 1, 1
    v_lshl_add_u32 v32, v34, 3, v32
    v_add_u32 v32, s83, v32
    v_lshl_add_u32 v35, v33, 4, v32
    v_accvgpr_write_b32 a190, v35
    v_xor_b32 v33, 2, v33
    v_lshl_add_u32 v35, v33, 4, v32
    v_add_u32 v35, 256, v35
    v_accvgpr_write_b32 a191, v35
    s_mul_i32 s93, s40, 458752
    s_lshl_b32 s83, s43, 7
    s_add_u32 s93, s93, s83
    s_lshl_b32 s94, s43, 16
    s_lshl_b32 s83, s40, 8
    s_add_u32 s94, s94, s83
    s_and_b32 s83, s40, 1
    s_lshl_b32 s83, s83, 15
    s_xor_b32 s90, s83, 0x8000
    s_add_u32 s90, s90, s94
    s_add_u32 s94, s94, s83
    v_lshlrev_b32 v0, 7, v1
    v_mov_b32 v25, 2146435072
    v_cmp_gt_u32 vcc, 16, v1
    s_nop 1
    v_cndmask_b32 v0, v25, v0, vcc
    s_lshr_b32 s95, s2, 3
    s_lshl_b32 s95, s95, 2
    s_add_u32 s95, s95, s40
    s_mul_i32 s95, s95, 14336
    s_mov_b32 s64, s28
    s_mov_b32 s65, s29
    s_mov_b32 s66, 1835008
    s_mov_b32 s67, 0x20000
    v_lshrrev_b32 v30, 2, v1
    v_and_b32 v31, 3, v1
    v_cmp_eq_u32 vcc, 3, v31
    v_lshlrev_b32 v31, 7, v31
    v_cmp_le_u32 s[86:87], 4, v30
    v_mul_u32_u24 v30, 3584, v30
    v_add_u32 v30, v30, v31
    s_or_b64 vcc, vcc, s[86:87]
    v_mov_b32 v31, 2146435072
    v_cndmask_b32 v30, v30, v31, vcc
    s_lshl_b32 s3, s38, 1
    s_and_b32 s82, s40, 1
    s_add_u32 s3, s3, s82
    s_mul_i32 s3, s3, 14336
    s_mul_i32 s82, s39, 224
    s_and_b32 s82, s82, 0xffffff80
    s_add_u32 s3, s3, s82
    v_lshrrev_b32 v25, 2, v1
    v_and_b32 v26, 3, v1
    v_cmp_eq_u32 vcc, 3, v26
    v_lshlrev_b32 v26, 7, v26
    v_cmp_le_u32 s[86:87], 8, v25
    v_mul_u32_u24 v25, 3584, v25
    v_add_u32 v25, v25, v26
    s_or_b64 vcc, vcc, s[86:87]
    v_mov_b32 v26, 2146435072
    v_cndmask_b32 v25, v25, v26, vcc
    s_lshl_b32 s81, s38, 1
    s_and_b32 s82, s40, 1
    s_add_u32 s81, s81, s82
    s_mul_i32 s81, s81, 28672
    s_mul_i32 s82, s39, 224
    s_and_b32 s82, s82, 0xffffff80
    s_add_u32 s81, s81, s82
    s_add_u32 s81, s81, 0
    buffer_load_dword a250, v25, s[52:55], s81 offen
    v_and_b32 v25, 7, v1
    v_lshlrev_b32 v25, 7, v25
    s_lshl_b32 s81, s39, 4
    s_add_u32 s81, s81, s38
    s_lshl_b32 s81, s81, 1
    s_and_b32 s82, s40, 1
    s_add_u32 s81, s81, s82
    s_lshl_b32 s81, s81, 10
    buffer_load_dword a250, v25, s[48:51], s81 offen
    s_waitcnt vmcnt(14)
    s_barrier
    ds_read_b128 a[0:3], v21 offset:0
    ds_read_b128 a[4:7], v22 offset:0
    ds_read_b128 a[128:131], v17 offset:0
    ds_read_b128 a[132:135], v17 offset:4096
    ds_read_b128 a[8:11], v23 offset:0
    ds_read_b128 a[12:15], v24 offset:0
    ds_read_b128 a[136:139], v18 offset:0
    ds_read_b128 a[140:143], v18 offset:4096
    s_waitcnt lgkmcnt(4)
    v_mfma_f32_32x32x16_bf16 v[144:159], a[0:3], a[128:131], 0
    ds_read_b128 a[144:147], v19 offset:0
    ds_read_b128 a[148:151], v19 offset:4096
    s_add_u32 m0, s80, 0
    s_add_u32 s74, s77, 0
    buffer_load_dwordx4 v8, s[52:55], s74 offen offset:0  lds
    buffer_load_dwordx4 v9, s[52:55], s74 offen offset:1024  lds
    v_mfma_f32_32x32x16_bf16 v[160:175], a[0:3], a[132:135], 0
    ds_read_b128 a[152:155], v20 offset:0
    ds_read_b128 a[156:159], v20 offset:4096
    buffer_load_dwordx4 v10, s[52:55], s74 offen offset:2048  lds
    buffer_load_dwordx4 v11, s[52:55], s74 offen offset:3072  lds
    s_add_u32 m0, s80, 4096
    s_waitcnt lgkmcnt(4)
    v_mfma_f32_32x32x16_bf16 v[144:159], a[4:7], a[136:139], v[144:159]
    buffer_load_dwordx4 v12, s[52:55], s74 offen offset:0  lds
    buffer_load_dwordx4 v13, s[52:55], s74 offen offset:1024  lds
    buffer_load_dwordx4 v14, s[52:55], s74 offen offset:2048  lds
    s_add_u32 m0, s79, 16384
    v_mfma_f32_32x32x16_bf16 v[160:175], a[4:7], a[140:143], v[160:175]
    s_add_u32 s73, s76, 256
    buffer_load_dwordx4 v6, s[48:51], s73 offen offset:0  lds
    buffer_load_dwordx4 v7, s[48:51], s73 offen offset:1024  lds
    s_waitcnt vmcnt(11)
    s_barrier
    s_waitcnt lgkmcnt(2)
    v_mfma_f32_32x32x16_bf16 v[144:159], a[8:11], a[144:147], v[144:159]
    ds_read_b128 a[16:19], v21 offset:16384
    ds_read_b128 a[20:23], v22 offset:16384
    s_add_u32 m0, s78, 0
    s_add_u32 s72, s75, 256
    buffer_load_dwordx4 v2, s[44:47], s72 offen offset:0  lds
    v_mfma_f32_32x32x16_bf16 v[160:175], a[8:11], a[148:151], v[160:175]
    ds_read_b128 a[128:131], v17 offset:8192
    ds_read_b128 a[132:135], v17 offset:12288
    buffer_load_dwordx4 v3, s[44:47], s72 offen offset:1024  lds
    s_waitcnt lgkmcnt(4)
    v_mfma_f32_32x32x16_bf16 v[144:159], a[12:15], a[152:155], v[144:159]
    ds_read_b128 a[136:139], v18 offset:8192
    ds_read_b128 a[140:143], v18 offset:12288
    buffer_load_dwordx4 v4, s[44:47], s72 offen offset:2048  lds
    v_mfma_f32_32x32x16_bf16 v[160:175], a[12:15], a[156:159], v[160:175]
    ds_read_b128 a[24:27], v23 offset:16384
    ds_read_b128 a[28:31], v24 offset:16384
    buffer_load_dwordx4 v5, s[44:47], s72 offen offset:3072  lds
    s_waitcnt vmcnt(6)
    s_barrier
    s_waitcnt lgkmcnt(4)
    v_mfma_f32_32x32x16_bf16 v[144:159], a[16:19], a[128:131], v[144:159]
    ds_read_b128 a[144:147], v19 offset:8192
    ds_read_b128 a[148:151], v19 offset:12288
    ds_read_b128 a[152:155], v20 offset:8192
    s_add_u32 m0, s79, 24576
    s_add_u32 s73, s76, 384
    v_mfma_f32_32x32x16_bf16 v[160:175], a[16:19], a[132:135], v[160:175]
    ds_read_b128 a[156:159], v20 offset:12288
    ds_read_b64_tr_b16 v[176:177], v15 offset:0
    ds_read_b64_tr_b16 v[178:179], v15 offset:896
    buffer_load_dwordx4 v6, s[48:51], s73 offen offset:0  lds
    s_waitcnt lgkmcnt(8)
    v_mfma_f32_32x32x16_bf16 v[144:159], a[20:23], a[136:139], v[144:159]
    ds_read_b64_tr_b16 v[180:181], v15 offset:32
    ds_read_b64_tr_b16 v[182:183], v15 offset:928
    ds_read_b64_tr_b16 v[184:185], v15 offset:64
    buffer_load_dwordx4 v7, s[48:51], s73 offen offset:1024  lds
    v_mfma_f32_32x32x16_bf16 v[160:175], a[20:23], a[140:143], v[160:175]
    ds_read_b64_tr_b16 v[186:187], v15 offset:960
    s_waitcnt lgkmcnt(8)
    v_mfma_f32_32x32x16_bf16 v[144:159], a[24:27], a[144:147], v[144:159]
    ds_read_b64_tr_b16 v[188:189], v15 offset:96
    ds_read_b64_tr_b16 v[190:191], v15 offset:992
    s_add_u32 m0, s80, 28928
    s_add_u32 s74, s77, 229376
    buffer_load_dwordx4 v8, s[52:55], s74 offen offset:0  lds
    buffer_load_dwordx4 v9, s[52:55], s74 offen offset:1024  lds
    v_mfma_f32_32x32x16_bf16 v[160:175], a[24:27], a[148:151], v[160:175]
    ds_read_b64_tr_b16 v[192:193], v15 offset:128
    ds_read_b64_tr_b16 v[194:195], v15 offset:1024
    buffer_load_dwordx4 v10, s[52:55], s74 offen offset:2048  lds
    buffer_load_dwordx4 v11, s[52:55], s74 offen offset:3072  lds
    s_waitcnt lgkmcnt(10)
    v_mfma_f32_32x32x16_bf16 v[144:159], a[28:31], a[152:155], v[144:159]
    ds_read_b64_tr_b16 v[196:197], v15 offset:160
    ds_read_b64_tr_b16 v[198:199], v15 offset:1056
    s_add_u32 m0, s78, 16384
    s_add_u32 s72, s75, 384
    buffer_load_dwordx4 v2, s[44:47], s72 offen offset:0  lds
    buffer_load_dwordx4 v3, s[44:47], s72 offen offset:1024  lds
    v_mfma_f32_32x32x16_bf16 v[160:175], a[28:31], a[156:159], v[160:175]
    ds_read_b64_tr_b16 v[200:201], v15 offset:192
    ds_read_b64_tr_b16 v[202:203], v15 offset:1088
    buffer_load_dwordx4 v4, s[44:47], s72 offen offset:2048  lds
    buffer_load_dwordx4 v5, s[44:47], s72 offen offset:3072  lds
    s_waitcnt lgkmcnt(8)
    v_mfma_f32_32x32x16_bf16 v[32:47], v[176:179], a[0:3], 0
    ds_read_b64_tr_b16 v[204:205], v15 offset:3584
    ds_read_b64_tr_b16 v[206:207], v15 offset:4480
    ds_read_b64_tr_b16 v[208:209], v15 offset:3616
    s_add_u32 m0, s80, 33024
    s_nop 0
    buffer_load_dwordx4 v12, s[52:55], s74 offen offset:0  lds
    v_mfma_f32_32x32x16_bf16 v[48:63], v[180:183], a[0:3], 0
    ds_read_b64_tr_b16 v[210:211], v15 offset:4512
    ds_read_b64_tr_b16 v[212:213], v15 offset:3648
    ds_read_b64_tr_b16 v[214:215], v15 offset:4544
    v_lshlrev_b32 v252, 16, v240
    v_and_b32 v253, 0xffff0000, v240
    v_mfma_f32_32x32x16_bf16 v[64:79], v[184:187], a[0:3], 0
    ds_read_b64_tr_b16 v[216:217], v15 offset:3680
    ds_read_b64_tr_b16 v[218:219], v15 offset:4576
    ds_read_b64_tr_b16 v[220:221], v15 offset:3712
    buffer_load_dwordx4 v13, s[52:55], s74 offen offset:1024  lds
    s_waitcnt lgkmcnt(9)
    v_mfma_f32_32x32x16_bf16 v[80:95], v[188:191], a[0:3], 0
    ds_read_b64_tr_b16 v[222:223], v15 offset:4608
    ds_read_b64_tr_b16 v[224:225], v15 offset:3744
    ds_read_b64_tr_b16 v[226:227], v15 offset:4640
    buffer_load_dwordx4 v14, s[52:55], s74 offen offset:2048  lds
    v_mfma_f32_32x32x16_bf16 v[96:111], v[192:195], a[0:3], 0
    ds_read_b64_tr_b16 v[228:229], v15 offset:3776
    ds_read_b64_tr_b16 v[230:231], v15 offset:4672
    v_lshlrev_b32 v250, 16, v232
    v_and_b32 v251, 0xffff0000, v232
    v_mul_f32 v250, v250, v252
    v_mul_f32 v251, v251, v253
    v_mfma_f32_32x32x16_bf16 v[112:127], v[196:199], a[0:3], 0
    v_cvt_pk_bf16_f32 v232, v250, v251
    v_lshlrev_b32 v250, 16, v232
    v_and_b32 v251, 0xffff0000, v232
    v_add_f32 v248, v250, v251
    v_lshlrev_b32 v250, 16, v236
    v_and_b32 v251, 0xffff0000, v236
    v_mfma_f32_32x32x16_bf16 v[128:143], v[200:203], a[0:3], 0
    v_mul_f32 v250, v250, v252
    v_mul_f32 v251, v251, v253
    v_cvt_pk_bf16_f32 v236, v250, v251
    v_lshlrev_b32 v250, 16, v236
    v_and_b32 v251, 0xffff0000, v236
    s_waitcnt lgkmcnt(8)
    v_mfma_f32_32x32x16_bf16 v[32:47], v[204:207], a[4:7], v[32:47]
    ds_read_b64_tr_b16 v[176:177], v15 offset:7168
    ds_read_b64_tr_b16 v[178:179], v15 offset:8064
    ds_read_b64_tr_b16 v[180:181], v15 offset:7200
    ds_read_b64_tr_b16 v[182:183], v15 offset:8096
    s_add_u32 m0, s80, 57856
    s_add_u32 s74, s77, 458752
    v_mfma_f32_32x32x16_bf16 v[48:63], v[208:211], a[4:7], v[48:63]
    ds_read_b64_tr_b16 v[184:185], v15 offset:7232
    ds_read_b64_tr_b16 v[186:187], v15 offset:8128
    ds_read_b64_tr_b16 v[188:189], v15 offset:7264
    ds_read_b64_tr_b16 v[190:191], v15 offset:8160
    buffer_load_dwordx4 v8, s[52:55], s74 offen offset:0  lds
    v_mfma_f32_32x32x16_bf16 v[64:79], v[212:215], a[4:7], v[64:79]
    ds_read_b64_tr_b16 v[192:193], v15 offset:7296
    ds_read_b64_tr_b16 v[194:195], v15 offset:8192
    ds_read_b64_tr_b16 v[196:197], v15 offset:7328
    ds_read_b64_tr_b16 v[198:199], v15 offset:8224
    v_add_f32 v249, v250, v251
    v_lshlrev_b32 v252, 16, v241
    s_waitcnt lgkmcnt(12)
    v_mfma_f32_32x32x16_bf16 v[80:95], v[216:219], a[4:7], v[80:95]
    ds_read_b64_tr_b16 v[200:201], v15 offset:7360
    ds_read_b64_tr_b16 v[202:203], v15 offset:8256
    s_waitcnt vmcnt(4)
    ds_read_b128 a[32:35], v21 offset:0
    buffer_load_dwordx4 v9, s[52:55], s74 offen offset:1024  lds
    v_mfma_f32_32x32x16_bf16 v[96:111], v[220:223], a[4:7], v[96:111]
    ds_read_b128 a[36:39], v22 offset:0
    ds_read_b128 a[40:43], v23 offset:0
    ds_read_b128 a[44:47], v24 offset:0
    ds_read_b128 a[48:51], v21 offset:16384
    v_and_b32 v253, 0xffff0000, v241
    v_lshlrev_b32 v250, 16, v233
    v_mfma_f32_32x32x16_bf16 v[112:127], v[224:227], a[4:7], v[112:127]
    ds_read_b128 a[52:55], v22 offset:16384
    ds_read_b128 a[56:59], v23 offset:16384
    ds_read_b128 a[60:63], v24 offset:16384
    buffer_load_dwordx4 v10, s[52:55], s74 offen offset:2048  lds
    v_mfma_f32_32x32x16_bf16 v[128:143], v[228:231], a[4:7], v[128:143]
    buffer_load_dwordx4 v11, s[52:55], s74 offen offset:3072  lds
    v_and_b32 v251, 0xffff0000, v233
    s_waitcnt lgkmcnt(15)
    v_mfma_f32_32x32x16_bf16 v[32:47], v[176:179], a[8:11], v[32:47]
    ds_read_b64_tr_b16 v[204:205], v15 offset:10752
    ds_read_b64_tr_b16 v[206:207], v15 offset:11648
    ds_read_b64_tr_b16 v[208:209], v15 offset:10784
    s_add_u32 m0, s80, 61952
    s_nop 0
    buffer_load_dwordx4 v12, s[52:55], s74 offen offset:0  lds
    v_mfma_f32_32x32x16_bf16 v[48:63], v[180:183], a[8:11], v[48:63]
    ds_read_b64_tr_b16 v[210:211], v15 offset:11680
    ds_read_b64_tr_b16 v[212:213], v15 offset:10816
    ds_read_b64_tr_b16 v[214:215], v15 offset:11712
    v_mul_f32 v250, v250, v252
    v_mul_f32 v251, v251, v253
    v_cvt_pk_bf16_f32 v233, v250, v251
    v_mfma_f32_32x32x16_bf16 v[64:79], v[184:187], a[8:11], v[64:79]
    ds_read_b64_tr_b16 v[216:217], v15 offset:10848
    ds_read_b64_tr_b16 v[218:219], v15 offset:11744
    ds_read_b64_tr_b16 v[220:221], v15 offset:10880
    buffer_load_dwordx4 v13, s[52:55], s74 offen offset:1024  lds
    s_waitcnt lgkmcnt(15)
    v_mfma_f32_32x32x16_bf16 v[80:95], v[188:191], a[8:11], v[80:95]
    ds_read_b64_tr_b16 v[222:223], v15 offset:11776
    ds_read_b64_tr_b16 v[224:225], v15 offset:10912
    ds_read_b64_tr_b16 v[226:227], v15 offset:11808
    buffer_load_dwordx4 v14, s[52:55], s74 offen offset:2048  lds
    v_mfma_f32_32x32x16_bf16 v[96:111], v[192:195], a[8:11], v[96:111]
    ds_read_b64_tr_b16 v[228:229], v15 offset:10944
    ds_read_b64_tr_b16 v[230:231], v15 offset:11840
    v_lshlrev_b32 v250, 16, v233
    v_and_b32 v251, 0xffff0000, v233
    v_add_f32 v248, v248, v250
    v_add_f32 v248, v248, v251
    v_mfma_f32_32x32x16_bf16 v[112:127], v[196:199], a[8:11], v[112:127]
    v_lshlrev_b32 v250, 16, v237
    v_and_b32 v251, 0xffff0000, v237
    v_mul_f32 v250, v250, v252
    v_mul_f32 v251, v251, v253
    v_cvt_pk_bf16_f32 v237, v250, v251
    v_lshlrev_b32 v250, 16, v237
    v_mfma_f32_32x32x16_bf16 v[128:143], v[200:203], a[8:11], v[128:143]
    v_and_b32 v251, 0xffff0000, v237
    v_add_f32 v249, v249, v250
    v_add_f32 v249, v249, v251
    s_waitcnt vmcnt(7) lgkmcnt(0)
    s_barrier
    v_mfma_f32_32x32x16_bf16 v[32:47], v[204:207], a[12:15], v[32:47]
    ds_read_b128 a[128:131], v17 offset:16384
    ds_read_b128 a[132:135], v17 offset:20480
    ds_read_b128 a[136:139], v18 offset:16384
    s_add_u32 m0, s78, 0
    s_add_u32 s72, s75, 512
    v_lshlrev_b32 v252, 16, v242
    v_mfma_f32_32x32x16_bf16 v[48:63], v[208:211], a[12:15], v[48:63]
    ds_read_b128 a[140:143], v18 offset:20480
    buffer_load_dwordx4 v2, s[44:47], s72 offen offset:0  lds
    buffer_load_dwordx4 v3, s[44:47], s72 offen offset:1024  lds
    v_mfma_f32_32x32x16_bf16 v[64:79], v[212:215], a[12:15], v[64:79]
    buffer_load_dwordx4 v4, s[44:47], s72 offen offset:2048  lds
    v_and_b32 v253, 0xffff0000, v242
    v_lshlrev_b32 v250, 16, v234
    v_mfma_f32_32x32x16_bf16 v[80:95], v[216:219], a[12:15], v[80:95]
    buffer_load_dwordx4 v5, s[44:47], s72 offen offset:3072  lds
    v_and_b32 v251, 0xffff0000, v234
    v_mul_f32 v250, v250, v252
    v_mfma_f32_32x32x16_bf16 v[96:111], v[220:223], a[12:15], v[96:111]
    v_mul_f32 v251, v251, v253
    v_cvt_pk_bf16_f32 v234, v250, v251
    v_lshlrev_b32 v250, 16, v234
    v_and_b32 v251, 0xffff0000, v234
    v_add_f32 v248, v248, v250
    v_add_f32 v248, v248, v251
    v_mfma_f32_32x32x16_bf16 v[112:127], v[224:227], a[12:15], v[112:127]
    v_lshlrev_b32 v250, 16, v238
    v_and_b32 v251, 0xffff0000, v238
    v_mfma_f32_32x32x16_bf16 v[128:143], v[228:231], a[12:15], v[128:143]
    s_waitcnt lgkmcnt(2)
    v_mfma_f32_32x32x16_bf16 v[144:159], a[32:35], a[128:131], v[144:159]
    ds_read_b128 a[144:147], v19 offset:16384
    ds_read_b128 a[148:151], v19 offset:20480
    s_add_u32 s101, s3, 917504
    buffer_load_dword a250, v30, s[52:55], s101 offen
    v_mul_f32 v250, v250, v252
    v_mfma_f32_32x32x16_bf16 v[160:175], a[32:35], a[132:135], v[160:175]
    ds_read_b128 a[152:155], v20 offset:16384
    ds_read_b128 a[156:159], v20 offset:20480
    s_add_u32 m0, s78, 16384
    s_add_u32 s72, s75, 640
    buffer_load_dwordx4 v2, s[44:47], s72 offen offset:0  lds
    v_mul_f32 v251, v251, v253
    s_waitcnt lgkmcnt(4)
    v_mfma_f32_32x32x16_bf16 v[144:159], a[36:39], a[136:139], v[144:159]
    buffer_load_dwordx4 v3, s[44:47], s72 offen offset:1024  lds
    buffer_load_dwordx4 v4, s[44:47], s72 offen offset:2048  lds
    v_mfma_f32_32x32x16_bf16 v[160:175], a[36:39], a[140:143], v[160:175]
    buffer_load_dwordx4 v5, s[44:47], s72 offen offset:3072  lds
    v_cvt_pk_bf16_f32 v238, v250, v251
    v_lshlrev_b32 v250, 16, v238
    s_waitcnt lgkmcnt(2)
    v_mfma_f32_32x32x16_bf16 v[144:159], a[40:43], a[144:147], v[144:159]
    ds_read_b128 a[128:131], v17 offset:24576
    ds_read_b128 a[132:135], v17 offset:28672
    s_add_u32 m0, s79, 0
    s_add_u32 s73, s76, 512
    buffer_load_dwordx4 v6, s[48:51], s73 offen offset:0  lds
    v_and_b32 v251, 0xffff0000, v238
    v_mfma_f32_32x32x16_bf16 v[160:175], a[40:43], a[148:151], v[160:175]
    ds_read_b128 a[136:139], v18 offset:24576
    ds_read_b128 a[140:143], v18 offset:28672
    buffer_load_dwordx4 v7, s[48:51], s73 offen offset:1024  lds
    v_add_f32 v249, v249, v250
    s_waitcnt lgkmcnt(4)
    v_mfma_f32_32x32x16_bf16 v[144:159], a[44:47], a[152:155], v[144:159]
    v_add_f32 v249, v249, v251
    v_lshlrev_b32 v252, 16, v243
    v_and_b32 v253, 0xffff0000, v243
    v_lshlrev_b32 v250, 16, v235
    v_and_b32 v251, 0xffff0000, v235
    v_mul_f32 v250, v250, v252
    v_mfma_f32_32x32x16_bf16 v[160:175], a[44:47], a[156:159], v[160:175]
    v_mul_f32 v251, v251, v253
    v_cvt_pk_bf16_f32 v235, v250, v251
    v_lshlrev_b32 v250, 16, v235
    v_and_b32 v251, 0xffff0000, v235
    v_add_f32 v248, v248, v250
    v_add_f32 v248, v248, v251
    s_waitcnt lgkmcnt(2)
    v_mfma_f32_32x32x16_bf16 v[144:159], a[48:51], a[128:131], v[144:159]
    ds_read_b128 a[144:147], v19 offset:24576
    ds_read_b128 a[148:151], v19 offset:28672
    ds_read_b128 a[152:155], v20 offset:24576
    s_add_u32 m0, s79, 8192
    s_add_u32 s73, s76, 640
    v_lshlrev_b32 v250, 16, v239
    v_and_b32 v251, 0xffff0000, v239
    v_mfma_f32_32x32x16_bf16 v[160:175], a[48:51], a[132:135], v[160:175]
    ds_read_b128 a[156:159], v20 offset:28672
    ds_read_b64_tr_b16 v[176:177], v15 offset:28928
    ds_read_b64_tr_b16 v[178:179], v15 offset:29824
    buffer_load_dwordx4 v6, s[48:51], s73 offen offset:0  lds
    v_mul_f32 v250, v250, v252
    s_waitcnt lgkmcnt(6)
    v_mfma_f32_32x32x16_bf16 v[144:159], a[52:55], a[136:139], v[144:159]
    ds_read_b64_tr_b16 v[180:181], v15 offset:28960
    ds_read_b64_tr_b16 v[182:183], v15 offset:29856
    ds_read_b64_tr_b16 v[184:185], v15 offset:28992
    buffer_load_dwordx4 v7, s[48:51], s73 offen offset:1024  lds
    v_mul_f32 v251, v251, v253
    v_mfma_f32_32x32x16_bf16 v[160:175], a[52:55], a[140:143], v[160:175]
    ds_read_b64_tr_b16 v[186:187], v15 offset:29888
    v_cvt_pk_bf16_f32 v239, v250, v251
    v_lshlrev_b32 v250, 16, v239
    v_and_b32 v251, 0xffff0000, v239
    v_add_f32 v249, v249, v250
    s_waitcnt lgkmcnt(8)
    v_mfma_f32_32x32x16_bf16 v[144:159], a[56:59], a[144:147], v[144:159]
    ds_read_b64_tr_b16 v[188:189], v15 offset:29024
    ds_read_b64_tr_b16 v[190:191], v15 offset:29920
    v_add_f32 v249, v249, v251
    v_add_f32_dpp v248, v248, v248 row_ror:8 row_mask:0xf bank_mask:0xf
    s_nop 0
    v_add_f32_dpp v249, v249, v249 row_ror:8 row_mask:0xf bank_mask:0xf
    v_add_f32_dpp v248, v248, v248 row_ror:4 row_mask:0xf bank_mask:0xf
    s_nop 0
    v_add_f32_dpp v249, v249, v249 row_ror:4 row_mask:0xf bank_mask:0xf
    v_mfma_f32_32x32x16_bf16 v[160:175], a[56:59], a[148:151], v[160:175]
    ds_read_b64_tr_b16 v[192:193], v15 offset:29056
    ds_read_b64_tr_b16 v[194:195], v15 offset:29952
    v_add_f32_dpp v248, v248, v248 row_ror:2 row_mask:0xf bank_mask:0xf
    v_add_f32_dpp v249, v249, v249 row_ror:2 row_mask:0xf bank_mask:0xf
    s_nop 0
    v_add_f32_dpp v248, v248, v248 row_ror:1 row_mask:0xf bank_mask:0xf
    v_add_f32_dpp v249, v249, v249 row_ror:1 row_mask:0xf bank_mask:0xf
    v_readlane_b32 s6, v248, 0
    s_waitcnt lgkmcnt(10)
    v_mfma_f32_32x32x16_bf16 v[144:159], a[60:63], a[152:155], v[144:159]
    ds_read_b64_tr_b16 v[196:197], v15 offset:29088
    ds_read_b64_tr_b16 v[198:199], v15 offset:29984
    v_readlane_b32 s7, v248, 16
    v_readlane_b32 s8, v248, 32
    v_readlane_b32 s9, v248, 48
    v_readlane_b32 s18, v249, 0
    v_readlane_b32 s19, v249, 16
    v_mfma_f32_32x32x16_bf16 v[160:175], a[60:63], a[156:159], v[160:175]
    ds_read_b64_tr_b16 v[200:201], v15 offset:29120
    ds_read_b64_tr_b16 v[202:203], v15 offset:30016
    v_readlane_b32 s30, v249, 32
    v_readlane_b32 s31, v249, 48
    v_mov_b32 v248, s6
    v_add_f32 v248, s7, v248
    s_waitcnt lgkmcnt(8)
    v_mfma_f32_32x32x16_bf16 v[32:47], v[176:179], a[16:19], v[32:47]
    ds_read_b64_tr_b16 v[204:205], v15 offset:32512
    ds_read_b64_tr_b16 v[206:207], v15 offset:33408
    ds_read_b64_tr_b16 v[208:209], v15 offset:32544
    s_add_u32 m0, s80, 0
    s_add_u32 s74, s77, 688128
    v_add_f32 v248, s8, v248
    v_mfma_f32_32x32x16_bf16 v[48:63], v[180:183], a[16:19], v[48:63]
    ds_read_b64_tr_b16 v[210:211], v15 offset:33440
    ds_read_b64_tr_b16 v[212:213], v15 offset:32576
    ds_read_b64_tr_b16 v[214:215], v15 offset:33472
    buffer_load_dwordx4 v8, s[52:55], s74 offen offset:0  lds
    v_add_f32 v248, s9, v248
    v_mfma_f32_32x32x16_bf16 v[64:79], v[184:187], a[16:19], v[64:79]
    ds_read_b64_tr_b16 v[216:217], v15 offset:32608
    ds_read_b64_tr_b16 v[218:219], v15 offset:33504
    ds_read_b64_tr_b16 v[220:221], v15 offset:32640
    buffer_load_dwordx4 v9, s[52:55], s74 offen offset:1024  lds
    v_mov_b32 v249, s18
    s_waitcnt lgkmcnt(9)
    v_mfma_f32_32x32x16_bf16 v[80:95], v[188:191], a[16:19], v[80:95]
    ds_read_b64_tr_b16 v[222:223], v15 offset:33536
    ds_read_b64_tr_b16 v[224:225], v15 offset:32672
    ds_read_b64_tr_b16 v[226:227], v15 offset:33568
    buffer_load_dwordx4 v10, s[52:55], s74 offen offset:2048  lds
    v_add_f32 v249, s19, v249
    v_mfma_f32_32x32x16_bf16 v[96:111], v[192:195], a[16:19], v[96:111]
    ds_read_b64_tr_b16 v[228:229], v15 offset:32704
    ds_read_b64_tr_b16 v[230:231], v15 offset:33600
    buffer_load_dwordx4 v11, s[52:55], s74 offen offset:3072  lds
    s_add_u32 m0, s80, 4096
    v_mfma_f32_32x32x16_bf16 v[112:127], v[196:199], a[16:19], v[112:127]
    buffer_load_dwordx4 v12, s[52:55], s74 offen offset:0  lds
    buffer_load_dwordx4 v13, s[52:55], s74 offen offset:1024  lds
    v_add_f32 v249, s30, v249
    v_mfma_f32_32x32x16_bf16 v[128:143], v[200:203], a[16:19], v[128:143]
    buffer_load_dwordx4 v14, s[52:55], s74 offen offset:2048  lds
    v_add_f32 v249, s31, v249
    v_cmp_eq_u32 vcc, 1, v1
    s_waitcnt lgkmcnt(8)
    v_mfma_f32_32x32x16_bf16 v[32:47], v[204:207], a[20:23], v[32:47]
    ds_read_b64_tr_b16 v[176:177], v15 offset:36096
    ds_read_b64_tr_b16 v[178:179], v15 offset:36992
    ds_read_b64_tr_b16 v[180:181], v15 offset:36128
    ds_read_b64_tr_b16 v[182:183], v15 offset:37024
    buffer_load_dword a250, v0, s[64:67], s95 offen
    v_cndmask_b32 v248, v248, v249, vcc
    v_cvt_pk_bf16_f32 v248, v248, v248
    v_mfma_f32_32x32x16_bf16 v[48:63], v[208:211], a[20:23], v[48:63]
    ds_read_b64_tr_b16 v[184:185], v15 offset:36160
    ds_read_b64_tr_b16 v[186:187], v15 offset:37056
    ds_read_b64_tr_b16 v[188:189], v15 offset:36192
    ds_read_b64_tr_b16 v[190:191], v15 offset:37088
    s_add_u32 s101, s3, 1376256
    buffer_load_dword a250, v30, s[52:55], s101 offen
    v_lshlrev_b32 v248, 16, v248
    s_mov_b32 s6, 0xbfb8aa3b
    v_mfma_f32_32x32x16_bf16 v[64:79], v[212:215], a[20:23], v[64:79]
    ds_read_b64_tr_b16 v[192:193], v15 offset:36224
    ds_read_b64_tr_b16 v[194:195], v15 offset:37120
    ds_read_b64_tr_b16 v[196:197], v15 offset:36256
    ds_read_b64_tr_b16 v[198:199], v15 offset:37152
    v_mul_f32 v248, s6, v248
    v_exp_f32 v248, v248
    s_waitcnt lgkmcnt(12)
    v_mfma_f32_32x32x16_bf16 v[80:95], v[216:219], a[20:23], v[80:95]
    ds_read_b64_tr_b16 v[200:201], v15 offset:36288
    ds_read_b64_tr_b16 v[202:203], v15 offset:37184
    s_waitcnt vmcnt(13)
    ds_read_b128 a[64:67], v21 offset:0
    s_add_u32 s95, s95, 2048
    v_add_f32 v248, 1.0, v248
    v_rcp_f32 v248, v248
    v_mfma_f32_32x32x16_bf16 v[96:111], v[220:223], a[20:23], v[96:111]
    ds_read_b128 a[68:71], v22 offset:0
    ds_read_b128 a[72:75], v23 offset:0
    ds_read_b128 a[76:79], v24 offset:0
    ds_read_b128 a[80:83], v21 offset:16384
    v_cvt_pk_bf16_f32 v248, v248, v248
    v_lshlrev_b32 v248, 16, v248
    v_lshlrev_b32 v250, 3, v1
    s_lshl_b32 s6, s38, 7
    v_mfma_f32_32x32x16_bf16 v[112:127], v[224:227], a[20:23], v[112:127]
    ds_read_b128 a[84:87], v22 offset:16384
    ds_read_b128 a[88:91], v23 offset:16384
    ds_read_b128 a[92:95], v24 offset:16384
    s_lshr_b32 s7, s39, 1
    s_lshl_b32 s7, s7, 4
    s_add_u32 s6, s6, s7
    s_lshl_b32 s7, s40, 2
    s_add_u32 s6, s6, s7
    v_mfma_f32_32x32x16_bf16 v[128:143], v[228:231], a[20:23], v[128:143]
    s_and_b32 s7, s39, 1
    s_add_u32 s6, s6, s7
    s_lshl_b32 s6, s6, 2
    s_add_u32 s6, s6, 11599872
    v_add_u32 v250, s6, v250
    v_mov_b32 v251, 2146435072
    s_waitcnt lgkmcnt(15)
    v_mfma_f32_32x32x16_bf16 v[32:47], v[176:179], a[24:27], v[32:47]
    ds_read_b64_tr_b16 v[204:205], v15 offset:39680
    ds_read_b64_tr_b16 v[206:207], v15 offset:40576
    ds_read_b64_tr_b16 v[208:209], v15 offset:39712
    v_cmp_gt_u32 vcc, 2, v1
    s_nop 1
    v_cndmask_b32 v250, v251, v250, vcc
    buffer_store_dword v248, v250, s[56:59], 0 offen sc1
    v_mfma_f32_32x32x16_bf16 v[48:63], v[180:183], a[24:27], v[48:63]
    ds_read_b64_tr_b16 v[210:211], v15 offset:40608
    ds_read_b64_tr_b16 v[212:213], v15 offset:39744
    ds_read_b64_tr_b16 v[214:215], v15 offset:40640
    s_lshl_b32 s6, s38, 7
    s_add_u32 s6, s6, 11632640
    s_or_b32 s7, s39, s40
    s_cmp_eq_u32 s7, 0
    s_cselect_b32 s6, s6, 2146435072
    v_mfma_f32_32x32x16_bf16 v[64:79], v[184:187], a[24:27], v[64:79]
    ds_read_b64_tr_b16 v[216:217], v15 offset:39776
    ds_read_b64_tr_b16 v[218:219], v15 offset:40672
    ds_read_b64_tr_b16 v[220:221], v15 offset:39808
    v_mov_b32 v250, 2146435072
    v_mov_b32 v251, s6
    v_cmp_eq_u32 vcc, 0, v1
    s_nop 1
    v_cndmask_b32 v250, v250, v251, vcc
    s_waitcnt lgkmcnt(15)
    v_mfma_f32_32x32x16_bf16 v[80:95], v[188:191], a[24:27], v[80:95]
    ds_read_b64_tr_b16 v[222:223], v15 offset:40704
    ds_read_b64_tr_b16 v[224:225], v15 offset:39840
    ds_read_b64_tr_b16 v[226:227], v15 offset:40736
    v_mov_b32 v252, 0
    v_mov_b32 v253, 0
    buffer_store_dwordx2 v[252:253], v250, s[56:59], 0 offen sc1
    v_mfma_f32_32x32x16_bf16 v[96:111], v[192:195], a[24:27], v[96:111]
    ds_read_b64_tr_b16 v[228:229], v15 offset:39872
    ds_read_b64_tr_b16 v[230:231], v15 offset:40768
    s_lshl_b32 s6, s38, 12
    s_lshl_b32 s7, s39, 8
    s_add_u32 s6, s6, s7
    s_add_u32 s6, s6, 11534336
    v_mfma_f32_32x32x16_bf16 v[112:127], v[196:199], a[24:27], v[112:127]
    s_cmp_eq_u32 s40, 0
    s_cselect_b32 s6, s6, 2146435072
    v_lshlrev_b32 v250, 3, v1
    v_add_u32 v250, s6, v250
    v_mov_b32 v251, 2146435072
    v_cmp_gt_u32 vcc, 32, v1
    s_nop 1
    v_cndmask_b32 v250, v251, v250, vcc
    v_mov_b32 v252, -1
    v_mfma_f32_32x32x16_bf16 v[128:143], v[200:203], a[24:27], v[128:143]
    v_mov_b32 v253, -1
    buffer_store_dwordx2 v[252:253], v250, s[56:59], 0 offen sc1
    s_waitcnt vmcnt(12) lgkmcnt(0)
    s_barrier
    v_mfma_f32_32x32x16_bf16 v[32:47], v[204:207], a[28:31], v[32:47]
    ds_read_b128 a[128:131], v17 offset:0
    ds_read_b128 a[132:135], v17 offset:4096
    ds_read_b128 a[136:139], v18 offset:0
    s_add_u32 m0, s78, 0
    s_add_u32 s72, s75, 768
    v_mfma_f32_32x32x16_bf16 v[48:63], v[208:211], a[28:31], v[48:63]
    ds_read_b128 a[140:143], v18 offset:4096
    buffer_load_dwordx4 v2, s[44:47], s72 offen offset:0  lds
    buffer_load_dwordx4 v3, s[44:47], s72 offen offset:1024  lds
    v_mfma_f32_32x32x16_bf16 v[64:79], v[212:215], a[28:31], v[64:79]
    buffer_load_dwordx4 v4, s[44:47], s72 offen offset:2048  lds
    buffer_load_dword a250, v0, s[64:67], s95 offen
    v_mfma_f32_32x32x16_bf16 v[80:95], v[216:219], a[28:31], v[80:95]
    buffer_load_dwordx4 v5, s[44:47], s72 offen offset:3072  lds
    s_add_u32 s95, s95, 2048
    v_mfma_f32_32x32x16_bf16 v[96:111], v[220:223], a[28:31], v[96:111]
    v_mfma_f32_32x32x16_bf16 v[112:127], v[224:227], a[28:31], v[112:127]
    v_mfma_f32_32x32x16_bf16 v[128:143], v[228:231], a[28:31], v[128:143]
    s_waitcnt lgkmcnt(2)
    v_mfma_f32_32x32x16_bf16 v[144:159], a[64:67], a[128:131], v[144:159]
    ds_read_b128 a[144:147], v19 offset:0
    ds_read_b128 a[148:151], v19 offset:4096
    s_add_u32 m0, s78, 16384
    s_add_u32 s72, s75, 896
    buffer_load_dwordx4 v2, s[44:47], s72 offen offset:0  lds
    v_mfma_f32_32x32x16_bf16 v[160:175], a[64:67], a[132:135], v[160:175]
    ds_read_b128 a[152:155], v20 offset:0
    ds_read_b128 a[156:159], v20 offset:4096
    buffer_load_dwordx4 v3, s[44:47], s72 offen offset:1024  lds
    s_waitcnt lgkmcnt(4)
    v_mfma_f32_32x32x16_bf16 v[144:159], a[68:71], a[136:139], v[144:159]
    buffer_load_dwordx4 v4, s[44:47], s72 offen offset:2048  lds
    v_lshlrev_b32 v244, 16, v244
    v_mfma_f32_32x32x16_bf16 v[160:175], a[68:71], a[140:143], v[160:175]
    buffer_load_dwordx4 v5, s[44:47], s72 offen offset:3072  lds
    v_lshlrev_b32 v245, 16, v245
    s_waitcnt lgkmcnt(2)
    v_mfma_f32_32x32x16_bf16 v[144:159], a[72:75], a[144:147], v[144:159]
    ds_read_b128 a[128:131], v17 offset:8192
    ds_read_b128 a[132:135], v17 offset:12288
    s_add_u32 m0, s79, 16384
    s_add_u32 s73, s76, 768
    buffer_load_dwordx4 v6, s[48:51], s73 offen offset:0  lds
    v_mfma_f32_32x32x16_bf16 v[160:175], a[72:75], a[148:151], v[160:175]
    ds_read_b128 a[136:139], v18 offset:8192
    ds_read_b128 a[140:143], v18 offset:12288
    buffer_load_dwordx4 v7, s[48:51], s73 offen offset:1024  lds
    s_waitcnt lgkmcnt(4)
    v_mfma_f32_32x32x16_bf16 v[144:159], a[76:79], a[152:155], v[144:159]
    v_lshlrev_b32 v246, 16, v246
    s_mov_b32 s6, 0x3fb8aa3b
    s_mov_b32 s7, 0x3e22f983
    s_mov_b32 s8, 0x41800000
    s_mov_b32 s9, 0x43000000
    v_mul_f32 v246, s6, v246
    v_mfma_f32_32x32x16_bf16 v[160:175], a[76:79], a[156:159], v[160:175]
    v_exp_f32 v246, v246
    v_lshrrev_b32 v234, 5, v1
    v_cvt_pk_bf16_f32 v246, v246, v246
    v_lshlrev_b32 v246, 16, v246
    s_waitcnt lgkmcnt(2)
    v_mfma_f32_32x32x16_bf16 v[144:159], a[80:83], a[128:131], v[144:159]
    ds_read_b128 a[144:147], v19 offset:8192
    ds_read_b128 a[148:151], v19 offset:12288
    ds_read_b128 a[152:155], v20 offset:8192
    s_add_u32 m0, s79, 24576
    s_add_u32 s73, s76, 896
    v_mul_f32 v232, v246, v244
    v_mfma_f32_32x32x16_bf16 v[160:175], a[80:83], a[132:135], v[160:175]
    ds_read_b128 a[156:159], v20 offset:12288
    ds_read_b64_tr_b16 v[176:177], v16 offset:0
    ds_read_b64_tr_b16 v[178:179], v16 offset:896
    buffer_load_dwordx4 v6, s[48:51], s73 offen offset:0  lds
    s_waitcnt lgkmcnt(6)
    v_mfma_f32_32x32x16_bf16 v[144:159], a[84:87], a[136:139], v[144:159]
    ds_read_b64_tr_b16 v[180:181], v16 offset:32
    ds_read_b64_tr_b16 v[182:183], v16 offset:928
    ds_read_b64_tr_b16 v[184:185], v16 offset:64
    buffer_load_dwordx4 v7, s[48:51], s73 offen offset:1024  lds
    v_mfma_f32_32x32x16_bf16 v[160:175], a[84:87], a[140:143], v[160:175]
    ds_read_b64_tr_b16 v[186:187], v16 offset:960
    v_mul_f32 v233, v246, v245
    v_mul_f32 v232, s6, v232
    v_mul_f32 v233, s7, v233
    s_lshl_b32 s18, s40, 1
    s_waitcnt lgkmcnt(8)
    v_mfma_f32_32x32x16_bf16 v[144:159], a[88:91], a[144:147], v[144:159]
    ds_read_b64_tr_b16 v[188:189], v16 offset:96
    ds_read_b64_tr_b16 v[190:191], v16 offset:992
    v_add_u32 v234, s18, v234
    v_lshlrev_b32 v234, 4, v234
    v_cvt_f32_u32 v234, v234
    s_mov_b32 s19, 0x41000000
    v_mfma_f32_32x32x16_bf16 v[160:175], a[88:91], a[148:151], v[160:175]
    ds_read_b64_tr_b16 v[192:193], v16 offset:128
    ds_read_b64_tr_b16 v[194:195], v16 offset:1024
    v_mul_f32 v235, s8, v232
    v_mul_f32 v236, s8, v233
    v_exp_f32 v235, v235
    s_waitcnt lgkmcnt(10)
    v_mfma_f32_32x32x16_bf16 v[144:159], a[92:95], a[152:155], v[144:159]
    ds_read_b64_tr_b16 v[196:197], v16 offset:160
    ds_read_b64_tr_b16 v[198:199], v16 offset:1056
    v_fract_f32 v236, v236
    v_cos_f32 v238, v236
    v_sin_f32 v239, v236
    v_mfma_f32_32x32x16_bf16 v[160:175], a[92:95], a[156:159], v[160:175]
    ds_read_b64_tr_b16 v[200:201], v16 offset:192
    ds_read_b64_tr_b16 v[202:203], v16 offset:1088
    s_nop 0
    v_mul_f32 v238, v235, v238
    v_mul_f32 v239, v235, v239
    s_waitcnt lgkmcnt(8)
    v_mfma_f32_32x32x16_bf16 v[32:47], v[176:179], a[32:35], v[32:47]
    ds_read_b64_tr_b16 v[204:205], v16 offset:3584
    ds_read_b64_tr_b16 v[206:207], v16 offset:4480
    ds_read_b64_tr_b16 v[208:209], v16 offset:3616
    s_add_u32 m0, s80, 28928
    s_add_u32 s74, s77, 917504
    v_accvgpr_write_b32 a162, v238
    v_mfma_f32_32x32x16_bf16 v[48:63], v[180:183], a[32:35], v[48:63]
    ds_read_b64_tr_b16 v[210:211], v16 offset:4512
    ds_read_b64_tr_b16 v[212:213], v16 offset:3648
    ds_read_b64_tr_b16 v[214:215], v16 offset:4544
    buffer_load_dwordx4 v8, s[52:55], s74 offen offset:0  lds
    v_mfma_f32_32x32x16_bf16 v[64:79], v[184:187], a[32:35], v[64:79]
    ds_read_b64_tr_b16 v[216:217], v16 offset:3680
    ds_read_b64_tr_b16 v[218:219], v16 offset:4576
    ds_read_b64_tr_b16 v[220:221], v16 offset:3712
    buffer_load_dwordx4 v9, s[52:55], s74 offen offset:1024  lds
    s_waitcnt lgkmcnt(9)
    v_mfma_f32_32x32x16_bf16 v[80:95], v[188:191], a[32:35], v[80:95]
    ds_read_b64_tr_b16 v[222:223], v16 offset:4608
    ds_read_b64_tr_b16 v[224:225], v16 offset:3744
    ds_read_b64_tr_b16 v[226:227], v16 offset:4640
    buffer_load_dwordx4 v10, s[52:55], s74 offen offset:2048  lds
    v_mfma_f32_32x32x16_bf16 v[96:111], v[192:195], a[32:35], v[96:111]
    ds_read_b64_tr_b16 v[228:229], v16 offset:3776
    ds_read_b64_tr_b16 v[230:231], v16 offset:4672
    buffer_load_dwordx4 v11, s[52:55], s74 offen offset:3072  lds
    s_add_u32 m0, s80, 33024
    v_mfma_f32_32x32x16_bf16 v[112:127], v[196:199], a[32:35], v[112:127]
    buffer_load_dwordx4 v12, s[52:55], s74 offen offset:0  lds
    buffer_load_dwordx4 v13, s[52:55], s74 offen offset:1024  lds
    v_mfma_f32_32x32x16_bf16 v[128:143], v[200:203], a[32:35], v[128:143]
    buffer_load_dwordx4 v14, s[52:55], s74 offen offset:2048  lds
    v_accvgpr_write_b32 a163, v239
    s_waitcnt lgkmcnt(8)
    v_mfma_f32_32x32x16_bf16 v[32:47], v[204:207], a[36:39], v[32:47]
    ds_read_b64_tr_b16 v[176:177], v16 offset:7168
    ds_read_b64_tr_b16 v[178:179], v16 offset:8064
    ds_read_b64_tr_b16 v[180:181], v16 offset:7200
    ds_read_b64_tr_b16 v[182:183], v16 offset:8096
    buffer_load_dword a250, v0, s[64:67], s95 offen
    v_mfma_f32_32x32x16_bf16 v[48:63], v[208:211], a[36:39], v[48:63]
    ds_read_b64_tr_b16 v[184:185], v16 offset:7232
    ds_read_b64_tr_b16 v[186:187], v16 offset:8128
    ds_read_b64_tr_b16 v[188:189], v16 offset:7264
    ds_read_b64_tr_b16 v[190:191], v16 offset:8160
    v_mul_f32 v235, s9, v232
    v_mul_f32 v236, s9, v233
    v_mfma_f32_32x32x16_bf16 v[64:79], v[212:215], a[36:39], v[64:79]
    ds_read_b64_tr_b16 v[192:193], v16 offset:7296
    ds_read_b64_tr_b16 v[194:195], v16 offset:8192
    ds_read_b64_tr_b16 v[196:197], v16 offset:7328
    ds_read_b64_tr_b16 v[198:199], v16 offset:8224
    s_add_u32 s95, s95, 2048
    s_waitcnt lgkmcnt(12)
    v_mfma_f32_32x32x16_bf16 v[80:95], v[216:219], a[36:39], v[80:95]
    ds_read_b64_tr_b16 v[200:201], v16 offset:7360
    ds_read_b64_tr_b16 v[202:203], v16 offset:8256
    s_waitcnt vmcnt(12)
    ds_read_b128 a[96:99], v21 offset:0
    v_exp_f32 v235, v235
    v_fract_f32 v236, v236
    v_mfma_f32_32x32x16_bf16 v[96:111], v[220:223], a[36:39], v[96:111]
    ds_read_b128 a[100:103], v22 offset:0
    ds_read_b128 a[104:107], v23 offset:0
    ds_read_b128 a[108:111], v24 offset:0
    ds_read_b128 a[112:115], v21 offset:16384
    v_cos_f32 v238, v236
    v_mfma_f32_32x32x16_bf16 v[112:127], v[224:227], a[36:39], v[112:127]
    ds_read_b128 a[116:119], v22 offset:16384
    ds_read_b128 a[120:123], v23 offset:16384
    ds_read_b128 a[124:127], v24 offset:16384
    v_sin_f32 v239, v236
    s_nop 0
    v_mfma_f32_32x32x16_bf16 v[128:143], v[228:231], a[36:39], v[128:143]
    v_mul_f32 v238, v235, v238
    v_mul_f32 v239, v235, v239
    v_accvgpr_write_b32 a164, v238
    v_accvgpr_write_b32 a165, v239
    v_mul_f32 v235, v234, v232
    s_waitcnt lgkmcnt(15)
    v_mfma_f32_32x32x16_bf16 v[32:47], v[176:179], a[40:43], v[32:47]
    ds_read_b64_tr_b16 v[204:205], v16 offset:10752
    ds_read_b64_tr_b16 v[206:207], v16 offset:11648
    ds_read_b64_tr_b16 v[208:209], v16 offset:10784
    buffer_load_dword a250, v0, s[64:67], s95 offen
    v_mfma_f32_32x32x16_bf16 v[48:63], v[180:183], a[40:43], v[48:63]
    ds_read_b64_tr_b16 v[210:211], v16 offset:11680
    ds_read_b64_tr_b16 v[212:213], v16 offset:10816
    ds_read_b64_tr_b16 v[214:215], v16 offset:11712
    s_add_u32 s95, s95, 2048
    v_mfma_f32_32x32x16_bf16 v[64:79], v[184:187], a[40:43], v[64:79]
    ds_read_b64_tr_b16 v[216:217], v16 offset:10848
    ds_read_b64_tr_b16 v[218:219], v16 offset:11744
    ds_read_b64_tr_b16 v[220:221], v16 offset:10880
    s_waitcnt lgkmcnt(15)
    v_mfma_f32_32x32x16_bf16 v[80:95], v[188:191], a[40:43], v[80:95]
    ds_read_b64_tr_b16 v[222:223], v16 offset:11776
    ds_read_b64_tr_b16 v[224:225], v16 offset:10912
    ds_read_b64_tr_b16 v[226:227], v16 offset:11808
    v_mfma_f32_32x32x16_bf16 v[96:111], v[192:195], a[40:43], v[96:111]
    ds_read_b64_tr_b16 v[228:229], v16 offset:10944
    ds_read_b64_tr_b16 v[230:231], v16 offset:11840
    v_mfma_f32_32x32x16_bf16 v[112:127], v[196:199], a[40:43], v[112:127]
    v_mfma_f32_32x32x16_bf16 v[128:143], v[200:203], a[40:43], v[128:143]
    s_waitcnt vmcnt(9) lgkmcnt(0)
    s_barrier
    v_mfma_f32_32x32x16_bf16 v[32:47], v[204:207], a[44:47], v[32:47]
    ds_read_b128 a[128:131], v17 offset:16384
    ds_read_b128 a[132:135], v17 offset:20480
    ds_read_b128 a[136:139], v18 offset:16384
    s_lshl_b32 s81, s38, 4
    s_cmp_eq_u32 s40, 0
    s_cselect_b32 s81, s81, 2146435072
    v_mfma_f32_32x32x16_bf16 v[48:63], v[208:211], a[44:47], v[48:63]
    ds_read_b128 a[140:143], v18 offset:20480
    v_mov_b32 v254, 2146435072
    v_mov_b32 v255, s81
    v_cmp_eq_u32 vcc, 0, v1
    s_nop 1
    v_cndmask_b32 v254, v254, v255, vcc
    v_mov_b32 v255, 1
    v_mfma_f32_32x32x16_bf16 v[64:79], v[212:215], a[44:47], v[64:79]
    buffer_atomic_add v255, v254, s[60:63], 0 offen sc1
    v_mul_f32 v236, v234, v233
    v_exp_f32 v235, v235
    v_mfma_f32_32x32x16_bf16 v[80:95], v[216:219], a[44:47], v[80:95]
    v_fract_f32 v236, v236
    v_cos_f32 v238, v236
    v_sin_f32 v239, v236
    v_mfma_f32_32x32x16_bf16 v[96:111], v[220:223], a[44:47], v[96:111]
    s_nop 0
    v_mul_f32 v238, v235, v238
    v_mul_f32 v239, v235, v239
    v_accvgpr_write_b32 a166, v238
    v_accvgpr_write_b32 a167, v239
    v_mul_f32 v235, s19, v232
    v_mfma_f32_32x32x16_bf16 v[112:127], v[224:227], a[44:47], v[112:127]
    v_mul_f32 v236, s19, v233
    v_exp_f32 v235, v235
    v_fract_f32 v236, v236
    v_cos_f32 v238, v236
    v_mfma_f32_32x32x16_bf16 v[128:143], v[228:231], a[44:47], v[128:143]
    v_sin_f32 v239, v236
    s_nop 0
    v_mul_f32 v238, v235, v238
    v_mul_f32 v239, v235, v239
    s_waitcnt lgkmcnt(2)
    v_mfma_f32_32x32x16_bf16 v[144:159], a[96:99], a[128:131], v[144:159]
    ds_read_b128 a[144:147], v19 offset:16384
    ds_read_b128 a[148:151], v19 offset:20480
    v_accvgpr_write_b32 a172, v238
    v_accvgpr_write_b32 a173, v239
    v_mov_b32 v235, v232
    v_mov_b32 v236, v233
    v_mfma_f32_32x32x16_bf16 v[160:175], a[96:99], a[132:135], v[160:175]
    ds_read_b128 a[152:155], v20 offset:16384
    ds_read_b128 a[156:159], v20 offset:20480
    v_exp_f32 v235, v235
    v_fract_f32 v236, v236
    v_cos_f32 v238, v236
    s_waitcnt lgkmcnt(4)
    v_mfma_f32_32x32x16_bf16 v[144:159], a[100:103], a[136:139], v[144:159]
    v_sin_f32 v239, v236
    s_nop 0
    v_mul_f32 v238, v235, v238
    v_mul_f32 v239, v235, v239
    v_mfma_f32_32x32x16_bf16 v[160:175], a[100:103], a[140:143], v[160:175]
    v_accvgpr_write_b32 a160, v238
    v_accvgpr_write_b32 a161, v239
    v_add_f32 v235, -1.0, v238
    v_mul_f32 v236, v244, v244
    v_fmac_f32 v236, v245, v245
    s_waitcnt lgkmcnt(2)
    v_mfma_f32_32x32x16_bf16 v[144:159], a[104:107], a[144:147], v[144:159]
    ds_read_b128 a[128:131], v17 offset:24576
    ds_read_b128 a[132:135], v17 offset:28672
    v_rcp_f32 v236, v236
    v_mul_f32 v240, v235, v244
    v_fmac_f32 v240, v239, v245
    v_mfma_f32_32x32x16_bf16 v[160:175], a[104:107], a[148:151], v[160:175]
    ds_read_b128 a[136:139], v18 offset:24576
    ds_read_b128 a[140:143], v18 offset:28672
    v_mul_f32 v241, v239, v244
    v_fma_f32 v241, -v235, v245, v241
    v_add_f32 v236, v236, v236
    v_mul_f32 v240, v240, v236
    s_waitcnt lgkmcnt(4)
    v_mfma_f32_32x32x16_bf16 v[144:159], a[108:111], a[152:155], v[144:159]
    v_mul_f32 v241, v241, v236
    v_accvgpr_write_b32 a168, v240
    v_accvgpr_write_b32 a169, v241
    v_mfma_f32_32x32x16_bf16 v[160:175], a[108:111], a[156:159], v[160:175]
    s_waitcnt lgkmcnt(2)
    v_mfma_f32_32x32x16_bf16 v[144:159], a[112:115], a[128:131], v[144:159]
    ds_read_b128 a[144:147], v19 offset:24576
    ds_read_b128 a[148:151], v19 offset:28672
    ds_read_b128 a[152:155], v20 offset:24576
    v_mfma_f32_32x32x16_bf16 v[160:175], a[112:115], a[132:135], v[160:175]
    ds_read_b128 a[156:159], v20 offset:28672
    ds_read_b64_tr_b16 v[176:177], v15 offset:0
    ds_read_b64_tr_b16 v[178:179], v15 offset:896
    s_waitcnt lgkmcnt(6)
    v_mfma_f32_32x32x16_bf16 v[144:159], a[116:119], a[136:139], v[144:159]
    ds_read_b64_tr_b16 v[180:181], v15 offset:32
    ds_read_b64_tr_b16 v[182:183], v15 offset:928
    ds_read_b64_tr_b16 v[184:185], v15 offset:64
    v_mfma_f32_32x32x16_bf16 v[160:175], a[116:119], a[140:143], v[160:175]
    ds_read_b64_tr_b16 v[186:187], v15 offset:960
    s_waitcnt lgkmcnt(8)
    v_mfma_f32_32x32x16_bf16 v[144:159], a[120:123], a[144:147], v[144:159]
    ds_read_b64_tr_b16 v[188:189], v15 offset:96
    ds_read_b64_tr_b16 v[190:191], v15 offset:992
    v_mfma_f32_32x32x16_bf16 v[160:175], a[120:123], a[148:151], v[160:175]
    ds_read_b64_tr_b16 v[192:193], v15 offset:128
    ds_read_b64_tr_b16 v[194:195], v15 offset:1024
    s_waitcnt lgkmcnt(10)
    v_mfma_f32_32x32x16_bf16 v[144:159], a[124:127], a[152:155], v[144:159]
    ds_read_b64_tr_b16 v[196:197], v15 offset:160
    ds_read_b64_tr_b16 v[198:199], v15 offset:1056
    v_mfma_f32_32x32x16_bf16 v[160:175], a[124:127], a[156:159], v[160:175]
    ds_read_b64_tr_b16 v[200:201], v15 offset:192
    ds_read_b64_tr_b16 v[202:203], v15 offset:1088
    s_waitcnt lgkmcnt(8)
    v_mfma_f32_32x32x16_bf16 v[32:47], v[176:179], a[48:51], v[32:47]
    ds_read_b64_tr_b16 v[204:205], v15 offset:3584
    ds_read_b64_tr_b16 v[206:207], v15 offset:4480
    ds_read_b64_tr_b16 v[208:209], v15 offset:3616
    s_add_u32 m0, s80, 57856
    s_add_u32 s74, s77, 1146880
    v_accvgpr_read_b32 v248, a160
    v_accvgpr_read_b32 v249, a161
    v_accvgpr_read_b32 v26, a172
    v_accvgpr_read_b32 v27, a173
    v_mfma_f32_32x32x16_bf16 v[48:63], v[180:183], a[48:51], v[48:63]
    ds_read_b64_tr_b16 v[210:211], v15 offset:4512
    ds_read_b64_tr_b16 v[212:213], v15 offset:3648
    ds_read_b64_tr_b16 v[214:215], v15 offset:4544
    buffer_load_dwordx4 v8, s[52:55], s74 offen offset:0  lds
    v_lshrrev_b32 v250, 5, v1
    s_lshl_b32 s81, s40, 1
    v_add_u32 v250, s81, v250
    v_mfma_f32_32x32x16_bf16 v[64:79], v[184:187], a[48:51], v[64:79]
    ds_read_b64_tr_b16 v[216:217], v15 offset:3680
    ds_read_b64_tr_b16 v[218:219], v15 offset:4576
    ds_read_b64_tr_b16 v[220:221], v15 offset:3712
    buffer_load_dwordx4 v9, s[52:55], s74 offen offset:1024  lds
    v_lshlrev_b32 v250, 8, v250
    v_and_b32 v251, 31, v1
    v_lshlrev_b32 v251, 3, v251
    s_waitcnt lgkmcnt(9)
    v_mfma_f32_32x32x16_bf16 v[80:95], v[188:191], a[48:51], v[80:95]
    ds_read_b64_tr_b16 v[222:223], v15 offset:4608
    ds_read_b64_tr_b16 v[224:225], v15 offset:3744
    ds_read_b64_tr_b16 v[226:227], v15 offset:4640
    buffer_load_dwordx4 v10, s[52:55], s74 offen offset:2048  lds
    v_add_u32 v251, 152320, v251
    v_add_u32 v250, v250, v251
    v_mfma_f32_32x32x16_bf16 v[96:111], v[192:195], a[48:51], v[96:111]
    ds_read_b64_tr_b16 v[228:229], v15 offset:3776
    ds_read_b64_tr_b16 v[230:231], v15 offset:4672
    buffer_load_dwordx4 v11, s[52:55], s74 offen offset:3072  lds
    s_add_u32 m0, s80, 61952
    v_fma_f32 v236, v248, v144, v146
    v_fma_f32 v238, v248, v160, v162
    v_fma_f32 v237, v248, v145, v147
    v_mfma_f32_32x32x16_bf16 v[112:127], v[196:199], a[48:51], v[112:127]
    buffer_load_dwordx4 v12, s[52:55], s74 offen offset:0  lds
    buffer_load_dwordx4 v13, s[52:55], s74 offen offset:1024  lds
    v_fma_f32 v239, v248, v161, v163
    v_fma_f32 v236, -v249, v160, v236
    v_fma_f32 v238, v249, v144, v238
    v_mfma_f32_32x32x16_bf16 v[128:143], v[200:203], a[48:51], v[128:143]
    buffer_load_dwordx4 v14, s[52:55], s74 offen offset:2048  lds
    v_fma_f32 v237, -v249, v161, v237
    v_fma_f32 v239, v249, v145, v239
    v_fma_f32 v232, v248, v236, v148
    v_fma_f32 v234, v248, v238, v164
    s_waitcnt lgkmcnt(8)
    v_mfma_f32_32x32x16_bf16 v[32:47], v[204:207], a[52:55], v[32:47]
    ds_read_b64_tr_b16 v[176:177], v15 offset:7168
    ds_read_b64_tr_b16 v[178:179], v15 offset:8064
    ds_read_b64_tr_b16 v[180:181], v15 offset:7200
    buffer_load_dword a250, v0, s[64:67], s95 offen
    v_fma_f32 v233, v248, v237, v149
    v_mfma_f32_32x32x16_bf16 v[48:63], v[208:211], a[52:55], v[48:63]
    ds_read_b64_tr_b16 v[182:183], v15 offset:8096
    ds_read_b64_tr_b16 v[184:185], v15 offset:7232
    ds_read_b64_tr_b16 v[186:187], v15 offset:8128
    s_add_u32 s95, s95, 2048
    v_fma_f32 v235, v248, v239, v165
    v_fma_f32 v232, -v249, v238, v232
    v_mfma_f32_32x32x16_bf16 v[64:79], v[212:215], a[52:55], v[64:79]
    ds_read_b64_tr_b16 v[188:189], v15 offset:7264
    ds_read_b64_tr_b16 v[190:191], v15 offset:8160
    ds_read_b64_tr_b16 v[192:193], v15 offset:7296
    v_fma_f32 v234, v249, v236, v234
    v_fma_f32 v233, -v249, v239, v233
    v_fma_f32 v235, v249, v237, v235
    v_fma_f32 v236, v248, v232, v150
    s_waitcnt lgkmcnt(9)
    v_mfma_f32_32x32x16_bf16 v[80:95], v[216:219], a[52:55], v[80:95]
    ds_read_b64_tr_b16 v[194:195], v15 offset:8192
    ds_read_b64_tr_b16 v[196:197], v15 offset:7328
    ds_read_b64_tr_b16 v[198:199], v15 offset:8224
    v_fma_f32 v238, v248, v234, v166
    v_fma_f32 v237, v248, v233, v151
    v_fma_f32 v239, v248, v235, v167
    v_mfma_f32_32x32x16_bf16 v[96:111], v[220:223], a[52:55], v[96:111]
    ds_read_b64_tr_b16 v[200:201], v15 offset:7360
    ds_read_b64_tr_b16 v[202:203], v15 offset:8256
    v_fma_f32 v236, -v249, v234, v236
    v_fma_f32 v238, v249, v232, v238
    v_fma_f32 v237, -v249, v235, v237
    v_fma_f32 v239, v249, v233, v239
    v_mfma_f32_32x32x16_bf16 v[112:127], v[224:227], a[52:55], v[112:127]
    v_fma_f32 v232, v248, v236, v152
    v_fma_f32 v234, v248, v238, v168
    v_fma_f32 v233, v248, v237, v153
    v_fma_f32 v235, v248, v239, v169
    v_fma_f32 v232, -v249, v238, v232
    v_fma_f32 v234, v249, v236, v234
    v_fma_f32 v233, -v249, v239, v233
    v_mfma_f32_32x32x16_bf16 v[128:143], v[228:231], a[52:55], v[128:143]
    v_fma_f32 v235, v249, v237, v235
    v_fma_f32 v236, v248, v232, v154
    v_fma_f32 v238, v248, v234, v170
    v_fma_f32 v237, v248, v233, v155
    v_fma_f32 v239, v248, v235, v171
    v_fma_f32 v236, -v249, v234, v236
    s_waitcnt lgkmcnt(8)
    v_mfma_f32_32x32x16_bf16 v[32:47], v[176:179], a[56:59], v[32:47]
    ds_read_b64_tr_b16 v[204:205], v15 offset:10752
    ds_read_b64_tr_b16 v[206:207], v15 offset:11648
    ds_read_b64_tr_b16 v[208:209], v15 offset:10784
    buffer_load_dword a250, v0, s[64:67], s95 offen
    v_fma_f32 v238, v249, v232, v238
    v_mfma_f32_32x32x16_bf16 v[48:63], v[180:183], a[56:59], v[48:63]
    ds_read_b64_tr_b16 v[210:211], v15 offset:11680
    ds_read_b64_tr_b16 v[212:213], v15 offset:10816
    ds_read_b64_tr_b16 v[214:215], v15 offset:11712
    s_add_u32 s95, s95, 2048
    v_fma_f32 v237, -v249, v235, v237
    v_fma_f32 v239, v249, v233, v239
    v_fma_f32 v232, v248, v236, v156
    v_mfma_f32_32x32x16_bf16 v[64:79], v[184:187], a[56:59], v[64:79]
    ds_read_b64_tr_b16 v[216:217], v15 offset:10848
    ds_read_b64_tr_b16 v[218:219], v15 offset:11744
    ds_read_b64_tr_b16 v[220:221], v15 offset:10880
    v_fma_f32 v234, v248, v238, v172
    v_fma_f32 v233, v248, v237, v157
    v_fma_f32 v235, v248, v239, v173
    v_fma_f32 v232, -v249, v238, v232
    s_waitcnt lgkmcnt(9)
    v_mfma_f32_32x32x16_bf16 v[80:95], v[188:191], a[56:59], v[80:95]
    ds_read_b64_tr_b16 v[222:223], v15 offset:11776
    ds_read_b64_tr_b16 v[224:225], v15 offset:10912
    ds_read_b64_tr_b16 v[226:227], v15 offset:11808
    v_fma_f32 v234, v249, v236, v234
    v_fma_f32 v233, -v249, v239, v233
    v_fma_f32 v235, v249, v237, v235
    v_mfma_f32_32x32x16_bf16 v[96:111], v[192:195], a[56:59], v[96:111]
    ds_read_b64_tr_b16 v[228:229], v15 offset:10944
    ds_read_b64_tr_b16 v[230:231], v15 offset:11840
    v_fma_f32 v236, v248, v232, v158
    v_fma_f32 v238, v248, v234, v174
    v_fma_f32 v237, v248, v233, v159
    v_fma_f32 v239, v248, v235, v175
    v_fma_f32 v236, -v249, v234, v236
    v_mfma_f32_32x32x16_bf16 v[112:127], v[196:199], a[56:59], v[112:127]
    v_fma_f32 v238, v249, v232, v238
    v_fma_f32 v237, -v249, v235, v237
    v_fma_f32 v239, v249, v233, v239
    v_fma_f32 v28, v26, v236, v237
    v_fma_f32 v29, v26, v238, v239
    v_fma_f32 v28, -v27, v238, v28
    v_fma_f32 v29, v27, v236, v29
    v_mfma_f32_32x32x16_bf16 v[128:143], v[200:203], a[56:59], v[128:143]
    v_accvgpr_write_b32 a174, v236
    v_accvgpr_write_b32 a175, v238
    ds_write_b64 v250, v[28:29]
    s_waitcnt lgkmcnt(0)
    s_waitcnt vmcnt(12)
    s_barrier
    v_mfma_f32_32x32x16_bf16 v[32:47], v[204:207], a[60:63], v[32:47]
    ds_read_b64_tr_b16 v[176:177], v15 offset:28928
    ds_read_b64_tr_b16 v[178:179], v15 offset:29824
    ds_read_b64_tr_b16 v[180:181], v15 offset:28960
    s_add_u32 m0, s80, 0
    s_add_u32 s74, s77, 1376256
    v_lshlrev_b32 v24, 4, v1
    v_mfma_f32_32x32x16_bf16 v[48:63], v[208:211], a[60:63], v[48:63]
    ds_read_b64_tr_b16 v[182:183], v15 offset:29856
    ds_read_b64_tr_b16 v[184:185], v15 offset:28992
    ds_read_b64_tr_b16 v[186:187], v15 offset:29888
    buffer_load_dwordx4 v8, s[52:55], s74 offen offset:0  lds
    v_mfma_f32_32x32x16_bf16 v[64:79], v[212:215], a[60:63], v[64:79]
    ds_read_b64_tr_b16 v[188:189], v15 offset:29024
    ds_read_b64_tr_b16 v[190:191], v15 offset:29920
    ds_read_b64_tr_b16 v[192:193], v15 offset:29056
    buffer_load_dwordx4 v9, s[52:55], s74 offen offset:1024  lds
    v_mfma_f32_32x32x16_bf16 v[80:95], v[216:219], a[60:63], v[80:95]
    ds_read_b64_tr_b16 v[194:195], v15 offset:29952
    ds_read_b64_tr_b16 v[196:197], v15 offset:29088
    ds_read_b64_tr_b16 v[198:199], v15 offset:29984
    buffer_load_dwordx4 v10, s[52:55], s74 offen offset:2048  lds
    v_mfma_f32_32x32x16_bf16 v[96:111], v[220:223], a[60:63], v[96:111]
    ds_read_b64_tr_b16 v[200:201], v15 offset:29120
    ds_read_b64_tr_b16 v[202:203], v15 offset:30016
    buffer_load_dwordx4 v11, s[52:55], s74 offen offset:3072  lds
    v_mfma_f32_32x32x16_bf16 v[112:127], v[224:227], a[60:63], v[112:127]
    v_mov_b32 v255, 2146435072
    s_cmp_eq_u32 s40, 0
    s_cselect_b32 s81, 16, 0
    v_cmp_gt_u32 vcc, s81, v1
    s_nop 1
    v_cndmask_b32 v24, v255, v24, vcc
    v_mfma_f32_32x32x16_bf16 v[128:143], v[228:231], a[60:63], v[128:143]
    buffer_load_dword v23, v24, s[60:63], 0 offen sc1
    v_accvgpr_read_b32 v248, a162
    v_accvgpr_read_b32 v249, a163
    ds_read_b64 v[26:27], v251
    ds_read_b64 v[232:233], v251 offset:256
    s_waitcnt lgkmcnt(10)
    v_mfma_f32_32x32x16_bf16 v[32:47], v[176:179], a[64:67], v[32:47]
    ds_read_b64_tr_b16 v[204:205], v15 offset:32512
    ds_read_b64_tr_b16 v[206:207], v15 offset:33408
    ds_read_b64_tr_b16 v[208:209], v15 offset:32544
    s_add_u32 m0, s80, 4096
    s_nop 0
    buffer_load_dwordx4 v12, s[52:55], s74 offen offset:0  lds
    ds_read_b64 v[234:235], v251 offset:512
    ds_read_b64 v[236:237], v251 offset:768
    ds_read_b64 v[238:239], v251 offset:1024
    v_mfma_f32_32x32x16_bf16 v[48:63], v[180:183], a[64:67], v[48:63]
    ds_read_b64_tr_b16 v[210:211], v15 offset:33440
    ds_read_b64_tr_b16 v[212:213], v15 offset:32576
    ds_read_b64_tr_b16 v[214:215], v15 offset:33472
    ds_read_b64 v[240:241], v251 offset:1280
    ds_read_b64 v[242:243], v251 offset:1536
    ds_read_b64 v[244:245], v251 offset:1792
    v_mov_b32 v252, 0
    v_mov_b32 v253, 0
    v_mfma_f32_32x32x16_bf16 v[64:79], v[184:187], a[64:67], v[64:79]
    ds_read_b64_tr_b16 v[216:217], v15 offset:32608
    ds_read_b64_tr_b16 v[218:219], v15 offset:33504
    ds_read_b64_tr_b16 v[220:221], v15 offset:32640
    buffer_load_dwordx4 v13, s[52:55], s74 offen offset:1024  lds
    s_lshl_b32 s85, s40, 1
    s_add_u32 s3, s85, 1
    s_waitcnt lgkmcnt(15)
    v_mfma_f32_32x32x16_bf16 v[80:95], v[188:191], a[64:67], v[80:95]
    ds_read_b64_tr_b16 v[222:223], v15 offset:33536
    ds_read_b64_tr_b16 v[224:225], v15 offset:32672
    ds_read_b64_tr_b16 v[226:227], v15 offset:33568
    buffer_load_dwordx4 v14, s[52:55], s74 offen offset:2048  lds
    s_cmp_eq_u32 s85, 1
    s_cselect_b32 s86, -1, 0
    v_mfma_f32_32x32x16_bf16 v[96:111], v[192:195], a[64:67], v[96:111]
    ds_read_b64_tr_b16 v[228:229], v15 offset:32704
    ds_read_b64_tr_b16 v[230:231], v15 offset:33600
    s_cmp_eq_u32 s3, 1
    s_cselect_b32 s87, -1, 0
    v_cndmask_b32 v252, v252, v26, s[86:87]
    v_cndmask_b32 v253, v253, v27, s[86:87]
    v_fma_f32 v28, v248, v26, v232
    v_fma_f32 v29, v248, v27, v233
    v_fma_f32 v28, -v249, v27, v28
    v_mfma_f32_32x32x16_bf16 v[112:127], v[196:199], a[64:67], v[112:127]
    v_fma_f32 v29, v249, v26, v29
    s_cmp_eq_u32 s85, 2
    s_cselect_b32 s86, -1, 0
    s_cmp_eq_u32 s3, 2
    s_cselect_b32 s87, -1, 0
    s_waitcnt lgkmcnt(15)
    v_cndmask_b32 v252, v252, v28, s[86:87]
    v_cndmask_b32 v253, v253, v29, s[86:87]
    v_mfma_f32_32x32x16_bf16 v[128:143], v[200:203], a[64:67], v[128:143]
    v_fma_f32 v26, v248, v28, v234
    v_fma_f32 v27, v248, v29, v235
    v_fma_f32 v26, -v249, v29, v26
    v_fma_f32 v27, v249, v28, v27
    s_cmp_eq_u32 s85, 3
    s_cselect_b32 s86, -1, 0
    s_cmp_eq_u32 s3, 3
    s_cselect_b32 s87, -1, 0
    s_waitcnt lgkmcnt(11)
    v_mfma_f32_32x32x16_bf16 v[32:47], v[204:207], a[68:71], v[32:47]
    ds_read_b64_tr_b16 v[176:177], v15 offset:36096
    ds_read_b64_tr_b16 v[178:179], v15 offset:36992
    ds_read_b64_tr_b16 v[180:181], v15 offset:36128
    buffer_load_dword a250, v0, s[64:67], s95 offen
    v_cndmask_b32 v252, v252, v26, s[86:87]
    v_mfma_f32_32x32x16_bf16 v[48:63], v[208:211], a[68:71], v[48:63]
    ds_read_b64_tr_b16 v[182:183], v15 offset:37024
    ds_read_b64_tr_b16 v[184:185], v15 offset:36160
    ds_read_b64_tr_b16 v[186:187], v15 offset:37056
    s_add_u32 s95, s95, 2048
    v_cndmask_b32 v253, v253, v27, s[86:87]
    v_fma_f32 v28, v248, v26, v236
    v_fma_f32 v29, v248, v27, v237
    v_fma_f32 v28, -v249, v27, v28
    v_mfma_f32_32x32x16_bf16 v[64:79], v[212:215], a[68:71], v[64:79]
    ds_read_b64_tr_b16 v[188:189], v15 offset:36192
    ds_read_b64_tr_b16 v[190:191], v15 offset:37088
    ds_read_b64_tr_b16 v[192:193], v15 offset:36224
    v_fma_f32 v29, v249, v26, v29
    s_cmp_eq_u32 s85, 4
    s_cselect_b32 s86, -1, 0
    s_cmp_eq_u32 s3, 4
    s_cselect_b32 s87, -1, 0
    s_waitcnt lgkmcnt(9)
    v_mfma_f32_32x32x16_bf16 v[80:95], v[216:219], a[68:71], v[80:95]
    ds_read_b64_tr_b16 v[194:195], v15 offset:37120
    ds_read_b64_tr_b16 v[196:197], v15 offset:36256
    ds_read_b64_tr_b16 v[198:199], v15 offset:37152
    v_cndmask_b32 v252, v252, v28, s[86:87]
    v_cndmask_b32 v253, v253, v29, s[86:87]
    v_fma_f32 v26, v248, v28, v238
    v_mfma_f32_32x32x16_bf16 v[96:111], v[220:223], a[68:71], v[96:111]
    ds_read_b64_tr_b16 v[200:201], v15 offset:36288
    ds_read_b64_tr_b16 v[202:203], v15 offset:37184
    v_fma_f32 v27, v248, v29, v239
    v_fma_f32 v26, -v249, v29, v26
    v_fma_f32 v27, v249, v28, v27
    s_cmp_eq_u32 s85, 5
    s_cselect_b32 s86, -1, 0
    v_mfma_f32_32x32x16_bf16 v[112:127], v[224:227], a[68:71], v[112:127]
    s_cmp_eq_u32 s3, 5
    s_cselect_b32 s87, -1, 0
    v_cndmask_b32 v252, v252, v26, s[86:87]
    v_cndmask_b32 v253, v253, v27, s[86:87]
    v_fma_f32 v28, v248, v26, v240
    v_fma_f32 v29, v248, v27, v241
    v_fma_f32 v28, -v249, v27, v28
    v_fma_f32 v29, v249, v26, v29
    v_mfma_f32_32x32x16_bf16 v[128:143], v[228:231], a[68:71], v[128:143]
    s_cmp_eq_u32 s85, 6
    s_cselect_b32 s86, -1, 0
    s_cmp_eq_u32 s3, 6
    s_cselect_b32 s87, -1, 0
    v_cndmask_b32 v252, v252, v28, s[86:87]
    v_cndmask_b32 v253, v253, v29, s[86:87]
    s_waitcnt lgkmcnt(8)
    v_mfma_f32_32x32x16_bf16 v[32:47], v[176:179], a[72:75], v[32:47]
    ds_read_b64_tr_b16 v[204:205], v15 offset:39680
    ds_read_b64_tr_b16 v[206:207], v15 offset:40576
    ds_read_b64_tr_b16 v[208:209], v15 offset:39712
    v_fma_f32 v26, v248, v28, v242
    v_fma_f32 v27, v248, v29, v243
    v_fma_f32 v26, -v249, v29, v26
    v_fma_f32 v27, v249, v28, v27
    v_mfma_f32_32x32x16_bf16 v[48:63], v[180:183], a[72:75], v[48:63]
    ds_read_b64_tr_b16 v[210:211], v15 offset:40608
    ds_read_b64_tr_b16 v[212:213], v15 offset:39744
    ds_read_b64_tr_b16 v[214:215], v15 offset:40640
    s_cmp_eq_u32 s85, 7
    s_cselect_b32 s86, -1, 0
    s_cmp_eq_u32 s3, 7
    s_cselect_b32 s87, -1, 0
    v_mfma_f32_32x32x16_bf16 v[64:79], v[184:187], a[72:75], v[64:79]
    ds_read_b64_tr_b16 v[216:217], v15 offset:39776
    ds_read_b64_tr_b16 v[218:219], v15 offset:40672
    ds_read_b64_tr_b16 v[220:221], v15 offset:39808
    v_cndmask_b32 v252, v252, v26, s[86:87]
    v_cndmask_b32 v253, v253, v27, s[86:87]
    v_fma_f32 v28, v248, v26, v244
    v_fma_f32 v29, v248, v27, v245
    v_fma_f32 v28, -v249, v27, v28
    s_waitcnt lgkmcnt(9)
    v_mfma_f32_32x32x16_bf16 v[80:95], v[188:191], a[72:75], v[80:95]
    ds_read_b64_tr_b16 v[222:223], v15 offset:40704
    ds_read_b64_tr_b16 v[224:225], v15 offset:39840
    ds_read_b64_tr_b16 v[226:227], v15 offset:40736
    v_fma_f32 v29, v249, v26, v29
    v_accvgpr_write_b32 a58, v252
    v_accvgpr_write_b32 a59, v253
    v_accvgpr_mov_b32 a50, a174
    v_accvgpr_mov_b32 a51, a175
    v_mfma_f32_32x32x16_bf16 v[96:111], v[192:195], a[72:75], v[96:111]
    ds_read_b64_tr_b16 v[228:229], v15 offset:39872
    ds_read_b64_tr_b16 v[230:231], v15 offset:40768
    s_lshl_b32 s81, s38, 12
    s_lshl_b32 s82, s39, 8
    s_add_u32 s81, s81, s82
    s_add_u32 s81, s81, 11534336
    s_cmp_eq_u32 s40, 0
    s_cselect_b32 s81, s81, 2146435072
    v_mfma_f32_32x32x16_bf16 v[112:127], v[196:199], a[72:75], v[112:127]
    v_lshlrev_b32 v30, 3, v1
    v_add_u32 v30, s81, v30
    v_mov_b32 v31, 2146435072
    v_cmp_gt_u32 vcc, 32, v1
    s_nop 1
    v_cndmask_b32 v30, v31, v30, vcc
    buffer_store_dwordx2 v[28:29], v30, s[56:59], 0 offen sc1
    v_mfma_f32_32x32x16_bf16 v[128:143], v[200:203], a[72:75], v[128:143]
    s_waitcnt vmcnt(5)
    s_cmp_lg_u32 s40, 0
    s_cbranch_scc1 L_back_g
    v_cmp_eq_u32 vcc, 16, v23
    s_lshl_b32 s81, 2, s38
    s_sub_u32 s81, s81, 1
    s_lshl_b32 s82, 1, s41
    s_or_b32 s81, s81, s82
    s_and_b32 s82, vcc_lo, s81
    s_cmp_eq_u32 s82, s81
    s_cbranch_scc0 L_slow_g
L_back_g:
    s_waitcnt lgkmcnt(0)
    s_barrier
    v_mfma_f32_32x32x16_bf16 v[32:47], v[204:207], a[76:79], v[32:47]
    ds_read_b64_tr_b16 v[176:177], v16 offset:0
    ds_read_b64_tr_b16 v[178:179], v16 offset:896
    ds_read_b64_tr_b16 v[180:181], v16 offset:32
    s_add_u32 m0, s80, 28928
    s_add_u32 s74, s77, 1605632
    v_accvgpr_mov_b32 a48, a160
    v_mfma_f32_32x32x16_bf16 v[48:63], v[208:211], a[76:79], v[48:63]
    ds_read_b64_tr_b16 v[182:183], v16 offset:928
    ds_read_b64_tr_b16 v[184:185], v16 offset:64
    ds_read_b64_tr_b16 v[186:187], v16 offset:960
    buffer_load_dwordx4 v8, s[52:55], s74 offen offset:0  lds
    v_mfma_f32_32x32x16_bf16 v[64:79], v[212:215], a[76:79], v[64:79]
    ds_read_b64_tr_b16 v[188:189], v16 offset:96
    ds_read_b64_tr_b16 v[190:191], v16 offset:992
    ds_read_b64_tr_b16 v[192:193], v16 offset:128
    buffer_load_dwordx4 v9, s[52:55], s74 offen offset:1024  lds
    v_mfma_f32_32x32x16_bf16 v[80:95], v[216:219], a[76:79], v[80:95]
    ds_read_b64_tr_b16 v[194:195], v16 offset:1024
    ds_read_b64_tr_b16 v[196:197], v16 offset:160
    ds_read_b64_tr_b16 v[198:199], v16 offset:1056
    buffer_load_dwordx4 v10, s[52:55], s74 offen offset:2048  lds
    v_mfma_f32_32x32x16_bf16 v[96:111], v[220:223], a[76:79], v[96:111]
    ds_read_b64_tr_b16 v[200:201], v16 offset:192
    ds_read_b64_tr_b16 v[202:203], v16 offset:1088
    buffer_load_dwordx4 v11, s[52:55], s74 offen offset:3072  lds
    v_mfma_f32_32x32x16_bf16 v[112:127], v[224:227], a[76:79], v[112:127]
    v_accvgpr_mov_b32 a49, a161
    v_accvgpr_mov_b32 a52, a164
    v_accvgpr_mov_b32 a53, a165
    v_accvgpr_mov_b32 a54, a166
    v_accvgpr_mov_b32 a55, a167
    v_accvgpr_mov_b32 a56, a168
    v_mfma_f32_32x32x16_bf16 v[128:143], v[228:231], a[76:79], v[128:143]
    v_accvgpr_mov_b32 a57, a169
    v_accvgpr_mov_b32 a60, a172
    v_accvgpr_mov_b32 a61, a173
    s_waitcnt lgkmcnt(8)
    v_mfma_f32_32x32x16_bf16 v[32:47], v[176:179], a[80:83], v[32:47]
    ds_read_b64_tr_b16 v[204:205], v16 offset:3584
    ds_read_b64_tr_b16 v[206:207], v16 offset:4480
    ds_read_b64_tr_b16 v[208:209], v16 offset:3616
    s_add_u32 m0, s80, 33024
    s_nop 0
    buffer_load_dwordx4 v12, s[52:55], s74 offen offset:0  lds
    v_mfma_f32_32x32x16_bf16 v[48:63], v[180:183], a[80:83], v[48:63]
    ds_read_b64_tr_b16 v[210:211], v16 offset:4512
    ds_read_b64_tr_b16 v[212:213], v16 offset:3648
    ds_read_b64_tr_b16 v[214:215], v16 offset:4544
    s_lshr_b32 s95, s2, 3
    s_lshl_b32 s95, s95, 2
    s_add_u32 s95, s95, s40
    v_mfma_f32_32x32x16_bf16 v[64:79], v[184:187], a[80:83], v[64:79]
    ds_read_b64_tr_b16 v[216:217], v16 offset:3680
    ds_read_b64_tr_b16 v[218:219], v16 offset:4576
    ds_read_b64_tr_b16 v[220:221], v16 offset:3712
    buffer_load_dwordx4 v13, s[52:55], s74 offen offset:1024  lds
    s_waitcnt lgkmcnt(9)
    v_mfma_f32_32x32x16_bf16 v[80:95], v[188:191], a[80:83], v[80:95]
    ds_read_b64_tr_b16 v[222:223], v16 offset:4608
    ds_read_b64_tr_b16 v[224:225], v16 offset:3744
    ds_read_b64_tr_b16 v[226:227], v16 offset:4640
    buffer_load_dwordx4 v14, s[52:55], s74 offen offset:2048  lds
    v_mfma_f32_32x32x16_bf16 v[96:111], v[192:195], a[80:83], v[96:111]
    ds_read_b64_tr_b16 v[228:229], v16 offset:3776
    ds_read_b64_tr_b16 v[230:231], v16 offset:4672
    s_cmp_lt_u32 s95, 64
    s_cselect_b32 s68, s14, s16
    s_cselect_b32 s69, s15, s17
    s_mov_b32 s70, 524288
    v_mfma_f32_32x32x16_bf16 v[112:127], v[196:199], a[80:83], v[112:127]
    s_mov_b32 s71, 0x20000
    s_and_b32 s95, s95, 63
    s_lshl_b32 s95, s95, 13
    buffer_load_dword a250, v0, s[68:71], s95 offen
    v_mfma_f32_32x32x16_bf16 v[128:143], v[200:203], a[80:83], v[128:143]
    s_add_u32 s95, s95, 2048
    s_waitcnt lgkmcnt(8)
    v_mfma_f32_32x32x16_bf16 v[32:47], v[204:207], a[84:87], v[32:47]
    ds_read_b64_tr_b16 v[176:177], v16 offset:7168
    ds_read_b64_tr_b16 v[178:179], v16 offset:8064
    ds_read_b64_tr_b16 v[180:181], v16 offset:7200
    buffer_load_dword a250, v0, s[68:71], s95 offen
    v_bfe_u32 v25, v1, 2, 1
    v_lshlrev_b32 v25, 4, v25
    v_mfma_f32_32x32x16_bf16 v[48:63], v[208:211], a[84:87], v[48:63]
    ds_read_b64_tr_b16 v[182:183], v16 offset:8096
    ds_read_b64_tr_b16 v[184:185], v16 offset:7232
    ds_read_b64_tr_b16 v[186:187], v16 offset:8128
    s_add_u32 s95, s95, 2048
    v_bfe_u32 v26, v1, 3, 2
    v_lshlrev_b32 v26, 2, v26
    v_add_u32 v25, v25, v26
    v_mfma_f32_32x32x16_bf16 v[64:79], v[212:215], a[84:87], v[64:79]
    ds_read_b64_tr_b16 v[188:189], v16 offset:7264
    ds_read_b64_tr_b16 v[190:191], v16 offset:8160
    ds_read_b64_tr_b16 v[192:193], v16 offset:7296
    v_and_b32 v26, 3, v1
    v_add_u32 v25, v25, v26
    v_lshlrev_b32 v25, 2, v25
    s_lshl_b32 s81, s38, 2
    s_add_u32 s81, s81, s40
    s_waitcnt lgkmcnt(9)
    v_mfma_f32_32x32x16_bf16 v[80:95], v[216:219], a[84:87], v[80:95]
    ds_read_b64_tr_b16 v[194:195], v16 offset:8192
    ds_read_b64_tr_b16 v[196:197], v16 offset:7328
    ds_read_b64_tr_b16 v[198:199], v16 offset:8224
    s_lshl_b32 s81, s81, 7
    s_add_u32 s81, s81, 11599872
    buffer_load_dword v14, v25, s[56:59], s81 offen sc1
    v_mfma_f32_32x32x16_bf16 v[96:111], v[220:223], a[84:87], v[96:111]
    ds_read_b64_tr_b16 v[200:201], v16 offset:7360
    ds_read_b64_tr_b16 v[202:203], v16 offset:8256
    v_lshrrev_b32 v26, 5, v1
    v_lshlrev_b32 v26, 6, v26
    v_mfma_f32_32x32x16_bf16 v[112:127], v[224:227], a[84:87], v[112:127]
    buffer_load_dwordx4 v[2:5], v26, s[56:59], s81 offen offset:0 sc1
    buffer_load_dwordx4 v[6:9], v26, s[56:59], s81 offen offset:16 sc1
    v_mfma_f32_32x32x16_bf16 v[128:143], v[228:231], a[84:87], v[128:143]
    buffer_load_dwordx4 v[10:13], v26, s[56:59], s81 offen offset:32 sc1
    buffer_load_dwordx4 v[18:21], v26, s[56:59], s81 offen offset:48 sc1
    s_waitcnt lgkmcnt(8)
    v_mfma_f32_32x32x16_bf16 v[32:47], v[176:179], a[88:91], v[32:47]
    ds_read_b64_tr_b16 v[204:205], v16 offset:10752
    ds_read_b64_tr_b16 v[206:207], v16 offset:11648
    ds_read_b64_tr_b16 v[208:209], v16 offset:10784
    buffer_load_dword a250, v0, s[68:71], s95 offen
    v_mfma_f32_32x32x16_bf16 v[48:63], v[180:183], a[88:91], v[48:63]
    ds_read_b64_tr_b16 v[210:211], v16 offset:11680
    ds_read_b64_tr_b16 v[212:213], v16 offset:10816
    ds_read_b64_tr_b16 v[214:215], v16 offset:11712
    s_add_u32 s95, s95, 2048
    v_mfma_f32_32x32x16_bf16 v[64:79], v[184:187], a[88:91], v[64:79]
    ds_read_b64_tr_b16 v[216:217], v16 offset:10848
    ds_read_b64_tr_b16 v[218:219], v16 offset:11744
    ds_read_b64_tr_b16 v[220:221], v16 offset:10880
    s_waitcnt lgkmcnt(9)
    v_mfma_f32_32x32x16_bf16 v[80:95], v[188:191], a[88:91], v[80:95]
    ds_read_b64_tr_b16 v[222:223], v16 offset:11776
    ds_read_b64_tr_b16 v[224:225], v16 offset:10912
    ds_read_b64_tr_b16 v[226:227], v16 offset:11808
    v_mfma_f32_32x32x16_bf16 v[96:111], v[192:195], a[88:91], v[96:111]
    ds_read_b64_tr_b16 v[228:229], v16 offset:10944
    ds_read_b64_tr_b16 v[230:231], v16 offset:11840
    v_mfma_f32_32x32x16_bf16 v[112:127], v[196:199], a[88:91], v[112:127]
    v_mfma_f32_32x32x16_bf16 v[128:143], v[200:203], a[88:91], v[128:143]
    s_waitcnt vmcnt(17) lgkmcnt(0)
    s_barrier
    v_mfma_f32_32x32x16_bf16 v[32:47], v[204:207], a[92:95], v[32:47]
    ds_read_b64_tr_b16 v[176:177], v15 offset:0
    ds_read_b64_tr_b16 v[178:179], v15 offset:896
    ds_read_b64_tr_b16 v[180:181], v15 offset:32
    buffer_load_dword a250, v0, s[68:71], s95 offen
    v_mfma_f32_32x32x16_bf16 v[48:63], v[208:211], a[92:95], v[48:63]
    ds_read_b64_tr_b16 v[182:183], v15 offset:928
    ds_read_b64_tr_b16 v[184:185], v15 offset:64
    ds_read_b64_tr_b16 v[186:187], v15 offset:960
    s_add_u32 s95, s95, 2048
    v_accvgpr_read_b32 v232, a176
    v_accvgpr_read_b32 v233, a177
    v_mfma_f32_32x32x16_bf16 v[64:79], v[212:215], a[92:95], v[64:79]
    ds_read_b64_tr_b16 v[188:189], v15 offset:96
    ds_read_b64_tr_b16 v[190:191], v15 offset:992
    ds_read_b64_tr_b16 v[192:193], v15 offset:128
    v_accvgpr_read_b32 v238, a182
    v_accvgpr_read_b32 v239, a183
    s_mov_b32 s64, s28
    v_mfma_f32_32x32x16_bf16 v[80:95], v[216:219], a[92:95], v[80:95]
    ds_read_b64_tr_b16 v[194:195], v15 offset:1024
    ds_read_b64_tr_b16 v[196:197], v15 offset:160
    ds_read_b64_tr_b16 v[198:199], v15 offset:1056
    s_mov_b32 s65, s29
    s_mov_b32 s66, 1835008
    s_mov_b32 s67, 0x20000
    v_mfma_f32_32x32x16_bf16 v[96:111], v[220:223], a[92:95], v[96:111]
    ds_read_b64_tr_b16 v[200:201], v15 offset:192
    ds_read_b64_tr_b16 v[202:203], v15 offset:1088
    v_accvgpr_read_b32 v234, a178
    v_accvgpr_read_b32 v235, a179
    v_accvgpr_read_b32 v236, a180
    v_accvgpr_read_b32 v237, a181
    v_mfma_f32_32x32x16_bf16 v[112:127], v[224:227], a[92:95], v[112:127]
    v_accvgpr_read_b32 v240, a184
    v_accvgpr_read_b32 v241, a185
    v_accvgpr_read_b32 v242, a186
    v_accvgpr_read_b32 v243, a187
    s_mov_b32 s48, s14
    s_mov_b32 s49, s15
    v_mfma_f32_32x32x16_bf16 v[128:143], v[228:231], a[92:95], v[128:143]
    s_mov_b32 s50, 524288
    s_mov_b32 s51, 0x20000
    s_mov_b32 s52, s16
    s_mov_b32 s53, s17
    s_mov_b32 s54, 524288
    s_waitcnt lgkmcnt(8)
    v_mfma_f32_32x32x16_bf16 v[32:47], v[176:179], a[96:99], v[32:47]
    ds_read_b64_tr_b16 v[204:205], v15 offset:3584
    ds_read_b64_tr_b16 v[206:207], v15 offset:4480
    ds_read_b64_tr_b16 v[208:209], v15 offset:3616
    s_mov_b32 s55, 0x20000
    v_mfma_f32_32x32x16_bf16 v[48:63], v[180:183], a[96:99], v[48:63]
    ds_read_b64_tr_b16 v[210:211], v15 offset:4512
    ds_read_b64_tr_b16 v[212:213], v15 offset:3648
    ds_read_b64_tr_b16 v[214:215], v15 offset:4544
    v_mfma_f32_32x32x16_bf16 v[64:79], v[184:187], a[96:99], v[64:79]
    ds_read_b64_tr_b16 v[216:217], v15 offset:3680
    ds_read_b64_tr_b16 v[218:219], v15 offset:4576
    ds_read_b64_tr_b16 v[220:221], v15 offset:3712
    s_waitcnt lgkmcnt(9)
    v_mfma_f32_32x32x16_bf16 v[80:95], v[188:191], a[96:99], v[80:95]
    ds_read_b64_tr_b16 v[222:223], v15 offset:4608
    ds_read_b64_tr_b16 v[224:225], v15 offset:3744
    ds_read_b64_tr_b16 v[226:227], v15 offset:4640
    v_mfma_f32_32x32x16_bf16 v[96:111], v[192:195], a[96:99], v[96:111]
    ds_read_b64_tr_b16 v[228:229], v15 offset:3776
    ds_read_b64_tr_b16 v[230:231], v15 offset:4672
    v_mfma_f32_32x32x16_bf16 v[112:127], v[196:199], a[96:99], v[112:127]
    v_mfma_f32_32x32x16_bf16 v[128:143], v[200:203], a[96:99], v[128:143]
    s_waitcnt lgkmcnt(8)
    v_mfma_f32_32x32x16_bf16 v[32:47], v[204:207], a[100:103], v[32:47]
    ds_read_b64_tr_b16 v[176:177], v15 offset:7168
    ds_read_b64_tr_b16 v[178:179], v15 offset:8064
    ds_read_b64_tr_b16 v[180:181], v15 offset:7200
    v_mfma_f32_32x32x16_bf16 v[48:63], v[208:211], a[100:103], v[48:63]
    ds_read_b64_tr_b16 v[182:183], v15 offset:8096
    ds_read_b64_tr_b16 v[184:185], v15 offset:7232
    ds_read_b64_tr_b16 v[186:187], v15 offset:8128
    v_mfma_f32_32x32x16_bf16 v[64:79], v[212:215], a[100:103], v[64:79]
    ds_read_b64_tr_b16 v[188:189], v15 offset:7264
    ds_read_b64_tr_b16 v[190:191], v15 offset:8160
    ds_read_b64_tr_b16 v[192:193], v15 offset:7296
    s_waitcnt lgkmcnt(9)
    v_mfma_f32_32x32x16_bf16 v[80:95], v[216:219], a[100:103], v[80:95]
    ds_read_b64_tr_b16 v[194:195], v15 offset:8192
    ds_read_b64_tr_b16 v[196:197], v15 offset:7328
    ds_read_b64_tr_b16 v[198:199], v15 offset:8224
    v_mfma_f32_32x32x16_bf16 v[96:111], v[220:223], a[100:103], v[96:111]
    ds_read_b64_tr_b16 v[200:201], v15 offset:7360
    ds_read_b64_tr_b16 v[202:203], v15 offset:8256
    v_mfma_f32_32x32x16_bf16 v[112:127], v[224:227], a[100:103], v[112:127]
    v_mfma_f32_32x32x16_bf16 v[128:143], v[228:231], a[100:103], v[128:143]
    s_waitcnt lgkmcnt(8)
    v_mfma_f32_32x32x16_bf16 v[32:47], v[176:179], a[104:107], v[32:47]
    ds_read_b64_tr_b16 v[204:205], v15 offset:10752
    ds_read_b64_tr_b16 v[206:207], v15 offset:11648
    ds_read_b64_tr_b16 v[208:209], v15 offset:10784
    v_mfma_f32_32x32x16_bf16 v[48:63], v[180:183], a[104:107], v[48:63]
    ds_read_b64_tr_b16 v[210:211], v15 offset:11680
    ds_read_b64_tr_b16 v[212:213], v15 offset:10816
    ds_read_b64_tr_b16 v[214:215], v15 offset:11712
    v_mfma_f32_32x32x16_bf16 v[64:79], v[184:187], a[104:107], v[64:79]
    ds_read_b64_tr_b16 v[216:217], v15 offset:10848
    ds_read_b64_tr_b16 v[218:219], v15 offset:11744
    ds_read_b64_tr_b16 v[220:221], v15 offset:10880
    s_waitcnt lgkmcnt(9)
    v_mfma_f32_32x32x16_bf16 v[80:95], v[188:191], a[104:107], v[80:95]
    ds_read_b64_tr_b16 v[222:223], v15 offset:11776
    ds_read_b64_tr_b16 v[224:225], v15 offset:10912
    ds_read_b64_tr_b16 v[226:227], v15 offset:11808
    v_mfma_f32_32x32x16_bf16 v[96:111], v[192:195], a[104:107], v[96:111]
    ds_read_b64_tr_b16 v[228:229], v15 offset:10944
    ds_read_b64_tr_b16 v[230:231], v15 offset:11840
    v_mfma_f32_32x32x16_bf16 v[112:127], v[196:199], a[104:107], v[112:127]
    v_mfma_f32_32x32x16_bf16 v[128:143], v[200:203], a[104:107], v[128:143]
    s_waitcnt vmcnt(9) lgkmcnt(0)
    s_barrier
    v_mfma_f32_32x32x16_bf16 v[32:47], v[204:207], a[108:111], v[32:47]
    ds_read_b64_tr_b16 v[176:177], v15 offset:28928
    ds_read_b64_tr_b16 v[178:179], v15 offset:29824
    ds_read_b64_tr_b16 v[180:181], v15 offset:28960
    v_mfma_f32_32x32x16_bf16 v[48:63], v[208:211], a[108:111], v[48:63]
    ds_read_b64_tr_b16 v[182:183], v15 offset:29856
    ds_read_b64_tr_b16 v[184:185], v15 offset:28992
    ds_read_b64_tr_b16 v[186:187], v15 offset:29888
    v_mfma_f32_32x32x16_bf16 v[64:79], v[212:215], a[108:111], v[64:79]
    ds_read_b64_tr_b16 v[188:189], v15 offset:29024
    ds_read_b64_tr_b16 v[190:191], v15 offset:29920
    ds_read_b64_tr_b16 v[192:193], v15 offset:29056
    v_mfma_f32_32x32x16_bf16 v[80:95], v[216:219], a[108:111], v[80:95]
    ds_read_b64_tr_b16 v[194:195], v15 offset:29952
    ds_read_b64_tr_b16 v[196:197], v15 offset:29088
    ds_read_b64_tr_b16 v[198:199], v15 offset:29984
    v_mfma_f32_32x32x16_bf16 v[96:111], v[220:223], a[108:111], v[96:111]
    ds_read_b64_tr_b16 v[200:201], v15 offset:29120
    ds_read_b64_tr_b16 v[202:203], v15 offset:30016
    v_mfma_f32_32x32x16_bf16 v[112:127], v[224:227], a[108:111], v[112:127]
    v_mfma_f32_32x32x16_bf16 v[128:143], v[228:231], a[108:111], v[128:143]
    s_waitcnt lgkmcnt(8)
    v_mfma_f32_32x32x16_bf16 v[32:47], v[176:179], a[112:115], v[32:47]
    ds_read_b64_tr_b16 v[204:205], v15 offset:32512
    ds_read_b64_tr_b16 v[206:207], v15 offset:33408
    ds_read_b64_tr_b16 v[208:209], v15 offset:32544
    v_mfma_f32_32x32x16_bf16 v[48:63], v[180:183], a[112:115], v[48:63]
    ds_read_b64_tr_b16 v[210:211], v15 offset:33440
    ds_read_b64_tr_b16 v[212:213], v15 offset:32576
    ds_read_b64_tr_b16 v[214:215], v15 offset:33472
    v_mfma_f32_32x32x16_bf16 v[64:79], v[184:187], a[112:115], v[64:79]
    ds_read_b64_tr_b16 v[216:217], v15 offset:32608
    ds_read_b64_tr_b16 v[218:219], v15 offset:33504
    ds_read_b64_tr_b16 v[220:221], v15 offset:32640
    s_waitcnt lgkmcnt(9)
    v_mfma_f32_32x32x16_bf16 v[80:95], v[188:191], a[112:115], v[80:95]
    ds_read_b64_tr_b16 v[222:223], v15 offset:33536
    ds_read_b64_tr_b16 v[224:225], v15 offset:32672
    ds_read_b64_tr_b16 v[226:227], v15 offset:33568
    v_mfma_f32_32x32x16_bf16 v[96:111], v[192:195], a[112:115], v[96:111]
    ds_read_b64_tr_b16 v[228:229], v15 offset:32704
    ds_read_b64_tr_b16 v[230:231], v15 offset:33600
    v_mfma_f32_32x32x16_bf16 v[112:127], v[196:199], a[112:115], v[112:127]
    v_mfma_f32_32x32x16_bf16 v[128:143], v[200:203], a[112:115], v[128:143]
    s_waitcnt lgkmcnt(8)
    v_mfma_f32_32x32x16_bf16 v[32:47], v[204:207], a[116:119], v[32:47]
    ds_read_b64_tr_b16 v[176:177], v15 offset:36096
    ds_read_b64_tr_b16 v[178:179], v15 offset:36992
    ds_read_b64_tr_b16 v[180:181], v15 offset:36128
    s_add_u32 s68, s36, 11534336
    s_addc_u32 s69, s37, 0
    s_mov_b32 s70, 65536
    v_mfma_f32_32x32x16_bf16 v[48:63], v[208:211], a[116:119], v[48:63]
    ds_read_b64_tr_b16 v[182:183], v15 offset:37024
    ds_read_b64_tr_b16 v[184:185], v15 offset:36160
    ds_read_b64_tr_b16 v[186:187], v15 offset:37056
    s_mov_b32 s71, 0x20000
    v_and_b32 v27, 31, v1
    v_lshlrev_b32 v27, 3, v27
    v_mfma_f32_32x32x16_bf16 v[64:79], v[212:215], a[116:119], v[64:79]
    ds_read_b64_tr_b16 v[188:189], v15 offset:36192
    ds_read_b64_tr_b16 v[190:191], v15 offset:37088
    ds_read_b64_tr_b16 v[192:193], v15 offset:36224
    s_lshl_b32 s82, s39, 8
    s_lshl_b32 s81, s38, 12
    s_add_u32 s81, s81, s82
    s_waitcnt lgkmcnt(9)
    v_mfma_f32_32x32x16_bf16 v[80:95], v[216:219], a[116:119], v[80:95]
    ds_read_b64_tr_b16 v[194:195], v15 offset:37120
    ds_read_b64_tr_b16 v[196:197], v15 offset:36256
    ds_read_b64_tr_b16 v[198:199], v15 offset:37152
    s_sub_u32 s81, s81, 4096
    v_add_u32 v27, s81, v27
    v_mfma_f32_32x32x16_bf16 v[96:111], v[220:223], a[116:119], v[96:111]
    ds_read_b64_tr_b16 v[200:201], v15 offset:36288
    ds_read_b64_tr_b16 v[202:203], v15 offset:37184
    buffer_load_dwordx2 a[0:1], v27, s[68:71], 0 offen sc1
    v_subrev_u32 v28, 4096, v27
    v_mfma_f32_32x32x16_bf16 v[112:127], v[224:227], a[116:119], v[112:127]
    buffer_load_dwordx2 a[2:3], v28, s[68:71], 0 offen sc1
    v_subrev_u32 v27, 4096, v28
    v_mfma_f32_32x32x16_bf16 v[128:143], v[228:231], a[116:119], v[128:143]
    buffer_load_dwordx2 a[4:5], v27, s[68:71], 0 offen sc1
    v_subrev_u32 v28, 4096, v27
    s_waitcnt lgkmcnt(8)
    v_mfma_f32_32x32x16_bf16 v[32:47], v[176:179], a[120:123], v[32:47]
    ds_read_b64_tr_b16 v[204:205], v15 offset:39680
    ds_read_b64_tr_b16 v[206:207], v15 offset:40576
    ds_read_b64_tr_b16 v[208:209], v15 offset:39712
    buffer_load_dwordx2 a[6:7], v28, s[68:71], 0 offen sc1
    v_mfma_f32_32x32x16_bf16 v[48:63], v[180:183], a[120:123], v[48:63]
    ds_read_b64_tr_b16 v[210:211], v15 offset:40608
    ds_read_b64_tr_b16 v[212:213], v15 offset:39744
    ds_read_b64_tr_b16 v[214:215], v15 offset:40640
    v_subrev_u32 v27, 4096, v28
    buffer_load_dwordx2 a[8:9], v27, s[68:71], 0 offen sc1
    v_mfma_f32_32x32x16_bf16 v[64:79], v[184:187], a[120:123], v[64:79]
    ds_read_b64_tr_b16 v[216:217], v15 offset:39776
    ds_read_b64_tr_b16 v[218:219], v15 offset:40672
    ds_read_b64_tr_b16 v[220:221], v15 offset:39808
    v_subrev_u32 v28, 4096, v27
    s_waitcnt lgkmcnt(9)
    v_mfma_f32_32x32x16_bf16 v[80:95], v[188:191], a[120:123], v[80:95]
    ds_read_b64_tr_b16 v[222:223], v15 offset:40704
    ds_read_b64_tr_b16 v[224:225], v15 offset:39840
    ds_read_b64_tr_b16 v[226:227], v15 offset:40736
    buffer_load_dwordx2 a[10:11], v28, s[68:71], 0 offen sc1
    v_mfma_f32_32x32x16_bf16 v[96:111], v[192:195], a[120:123], v[96:111]
    ds_read_b64_tr_b16 v[228:229], v15 offset:39872
    ds_read_b64_tr_b16 v[230:231], v15 offset:40768
    v_subrev_u32 v27, 4096, v28
    buffer_load_dwordx2 a[12:13], v27, s[68:71], 0 offen sc1
    v_mfma_f32_32x32x16_bf16 v[112:127], v[196:199], a[120:123], v[112:127]
    v_subrev_u32 v28, 4096, v27
    buffer_load_dwordx2 a[14:15], v28, s[68:71], 0 offen sc1
    v_mfma_f32_32x32x16_bf16 v[128:143], v[200:203], a[120:123], v[128:143]
    v_subrev_u32 v27, 4096, v28
    s_waitcnt lgkmcnt(0)
    s_barrier
    v_mfma_f32_32x32x16_bf16 v[32:47], v[204:207], a[124:127], v[32:47]
    buffer_load_dwordx2 a[16:17], v27, s[68:71], 0 offen sc1
    v_subrev_u32 v28, 4096, v27
    buffer_load_dwordx2 a[18:19], v28, s[68:71], 0 offen sc1
    v_mfma_f32_32x32x16_bf16 v[48:63], v[208:211], a[124:127], v[48:63]
    v_subrev_u32 v27, 4096, v28
    buffer_load_dwordx2 a[20:21], v27, s[68:71], 0 offen sc1
    v_mfma_f32_32x32x16_bf16 v[64:79], v[212:215], a[124:127], v[64:79]
    v_subrev_u32 v28, 4096, v27
    buffer_load_dwordx2 a[22:23], v28, s[68:71], 0 offen sc1
    v_mfma_f32_32x32x16_bf16 v[80:95], v[216:219], a[124:127], v[80:95]
    v_subrev_u32 v27, 4096, v28
    buffer_load_dwordx2 a[24:25], v27, s[68:71], 0 offen sc1
    v_subrev_u32 v28, 4096, v27
    v_mfma_f32_32x32x16_bf16 v[96:111], v[220:223], a[124:127], v[96:111]
    buffer_load_dwordx2 a[26:27], v28, s[68:71], 0 offen sc1
    v_subrev_u32 v27, 4096, v28
    v_mfma_f32_32x32x16_bf16 v[112:127], v[224:227], a[124:127], v[112:127]
    buffer_load_dwordx2 a[28:29], v27, s[68:71], 0 offen sc1
    v_mfma_f32_32x32x16_bf16 v[128:143], v[228:231], a[124:127], v[128:143]
    s_nop 7
    s_waitcnt vmcnt(21)
    v_sub_f32 v178, 1.0, v14
    s_mov_b32 s81, 0xbdd2d3e8
    v_cvt_pk_bf16_f32 v178, v178, v178
    v_mov_b32 v176, s81
    v_lshlrev_b32 v178, 16, v178
    s_mov_b32 s81, 0xc0135761
    v_rcp_f32 v178, v178
    v_mov_b32 v177, s81
    s_mov_b32 s81, 0x7149f2ca
    v_min_f32 v178, s81, v178
    s_lshl_b32 s91, s38, 2
    s_add_u32 s91, s91, s40
    s_mul_i32 s91, s91, 176
    s_mul_i32 s81, s39, 11
    s_add_u32 s91, s91, s81
    s_lshl_b32 s91, s91, 10
    v_lshlrev_b32 v22, 4, v1
    v_pk_mul_f32 v[180:181], v[32:33], v[32:33]
    v_pk_mul_f32 v[182:183], v[34:35], v[34:35]
    v_pk_mul_f32 v[184:185], v[40:41], v[40:41]
    v_pk_mul_f32 v[186:187], v[42:43], v[42:43]
    v_pk_fma_f32 v[180:181], v[180:181], v[176:177], v[176:177] op_sel:[0,0,1] op_sel_hi:[1,0,1]
    v_pk_fma_f32 v[182:183], v[182:183], v[176:177], v[176:177] op_sel:[0,0,1] op_sel_hi:[1,0,1]
    v_pk_fma_f32 v[184:185], v[184:185], v[176:177], v[176:177] op_sel:[0,0,1] op_sel_hi:[1,0,1]
    v_pk_fma_f32 v[186:187], v[186:187], v[176:177], v[176:177] op_sel:[0,0,1] op_sel_hi:[1,0,1]
    v_pk_mul_f32 v[180:181], v[32:33], v[180:181]
    v_pk_mul_f32 v[182:183], v[34:35], v[182:183]
    v_pk_mul_f32 v[184:185], v[40:41], v[184:185]
    v_pk_mul_f32 v[186:187], v[42:43], v[186:187]
    v_exp_f32 v180, v180
    v_exp_f32 v181, v181
    v_pk_mul_f32 v[188:189], v[32:33], v[36:37]
    v_exp_f32 v182, v182
    v_exp_f32 v183, v183
    v_pk_mul_f32 v[190:191], v[34:35], v[38:39]
    v_exp_f32 v184, v184
    v_exp_f32 v185, v185
    v_pk_mul_f32 v[192:193], v[40:41], v[44:45]
    v_exp_f32 v186, v186
    v_exp_f32 v187, v187
    v_pk_mul_f32 v[194:195], v[42:43], v[46:47]
    v_pk_fma_f32 v[180:181], v[180:181], v[178:179], v[178:179] op_sel:[0,0,0] op_sel_hi:[1,0,0]
    v_pk_fma_f32 v[182:183], v[182:183], v[178:179], v[178:179] op_sel:[0,0,0] op_sel_hi:[1,0,0]
    v_pk_fma_f32 v[184:185], v[184:185], v[178:179], v[178:179] op_sel:[0,0,0] op_sel_hi:[1,0,0]
    v_pk_fma_f32 v[186:187], v[186:187], v[178:179], v[178:179] op_sel:[0,0,0] op_sel_hi:[1,0,0]
    v_rcp_f32 v180, v180
    v_rcp_f32 v181, v181
    v_rcp_f32 v182, v182
    v_rcp_f32 v183, v183
    v_rcp_f32 v184, v184
    v_rcp_f32 v185, v185
    v_rcp_f32 v186, v186
    v_rcp_f32 v187, v187
    v_pk_mul_f32 v[188:189], v[188:189], v[180:181]
    v_pk_mul_f32 v[190:191], v[190:191], v[182:183]
    v_pk_mul_f32 v[192:193], v[192:193], v[184:185]
    v_pk_mul_f32 v[194:195], v[194:195], v[186:187]
    v_cvt_pk_bf16_f32 v32, v188, v189
    v_cvt_pk_bf16_f32 v33, v190, v191
    v_cvt_pk_bf16_f32 v34, v192, v193
    v_cvt_pk_bf16_f32 v35, v194, v195
    buffer_store_dwordx4 v[32:35], v22, s[56:59], s91 offen offset:0 sc1
    v_pk_mul_f32 v[196:197], v[48:49], v[48:49]
    v_pk_mul_f32 v[198:199], v[50:51], v[50:51]
    v_pk_mul_f32 v[200:201], v[56:57], v[56:57]
    v_pk_mul_f32 v[202:203], v[58:59], v[58:59]
    v_pk_fma_f32 v[196:197], v[196:197], v[176:177], v[176:177] op_sel:[0,0,1] op_sel_hi:[1,0,1]
    v_pk_fma_f32 v[198:199], v[198:199], v[176:177], v[176:177] op_sel:[0,0,1] op_sel_hi:[1,0,1]
    v_pk_fma_f32 v[200:201], v[200:201], v[176:177], v[176:177] op_sel:[0,0,1] op_sel_hi:[1,0,1]
    v_pk_fma_f32 v[202:203], v[202:203], v[176:177], v[176:177] op_sel:[0,0,1] op_sel_hi:[1,0,1]
    v_pk_mul_f32 v[196:197], v[48:49], v[196:197]
    v_pk_mul_f32 v[198:199], v[50:51], v[198:199]
    v_pk_mul_f32 v[200:201], v[56:57], v[200:201]
    v_pk_mul_f32 v[202:203], v[58:59], v[202:203]
    v_exp_f32 v196, v196
    v_exp_f32 v197, v197
    v_pk_mul_f32 v[204:205], v[48:49], v[52:53]
    v_exp_f32 v198, v198
    v_exp_f32 v199, v199
    v_pk_mul_f32 v[206:207], v[50:51], v[54:55]
    v_exp_f32 v200, v200
    v_exp_f32 v201, v201
    v_pk_mul_f32 v[208:209], v[56:57], v[60:61]
    v_exp_f32 v202, v202
    v_exp_f32 v203, v203
    v_pk_mul_f32 v[210:211], v[58:59], v[62:63]
    v_pk_fma_f32 v[196:197], v[196:197], v[178:179], v[178:179] op_sel:[0,0,0] op_sel_hi:[1,0,0]
    v_pk_fma_f32 v[198:199], v[198:199], v[178:179], v[178:179] op_sel:[0,0,0] op_sel_hi:[1,0,0]
    v_pk_fma_f32 v[200:201], v[200:201], v[178:179], v[178:179] op_sel:[0,0,0] op_sel_hi:[1,0,0]
    v_pk_fma_f32 v[202:203], v[202:203], v[178:179], v[178:179] op_sel:[0,0,0] op_sel_hi:[1,0,0]
    v_rcp_f32 v196, v196
    v_rcp_f32 v197, v197
    v_rcp_f32 v198, v198
    v_rcp_f32 v199, v199
    v_rcp_f32 v200, v200
    v_rcp_f32 v201, v201
    v_rcp_f32 v202, v202
    v_rcp_f32 v203, v203
    v_pk_mul_f32 v[204:205], v[204:205], v[196:197]
    v_pk_mul_f32 v[206:207], v[206:207], v[198:199]
    v_pk_mul_f32 v[208:209], v[208:209], v[200:201]
    v_pk_mul_f32 v[210:211], v[210:211], v[202:203]
    v_cvt_pk_bf16_f32 v48, v204, v205
    v_cvt_pk_bf16_f32 v49, v206, v207
    v_cvt_pk_bf16_f32 v50, v208, v209
    v_cvt_pk_bf16_f32 v51, v210, v211
    buffer_store_dwordx4 v[48:51], v22, s[56:59], s91 offen offset:1024 sc1
    v_pk_mul_f32 v[180:181], v[64:65], v[64:65]
    v_pk_mul_f32 v[182:183], v[66:67], v[66:67]
    v_pk_mul_f32 v[184:185], v[72:73], v[72:73]
    v_pk_mul_f32 v[186:187], v[74:75], v[74:75]
    v_pk_fma_f32 v[180:181], v[180:181], v[176:177], v[176:177] op_sel:[0,0,1] op_sel_hi:[1,0,1]
    v_pk_fma_f32 v[182:183], v[182:183], v[176:177], v[176:177] op_sel:[0,0,1] op_sel_hi:[1,0,1]
    v_pk_fma_f32 v[184:185], v[184:185], v[176:177], v[176:177] op_sel:[0,0,1] op_sel_hi:[1,0,1]
    v_pk_fma_f32 v[186:187], v[186:187], v[176:177], v[176:177] op_sel:[0,0,1] op_sel_hi:[1,0,1]
    v_pk_mul_f32 v[180:181], v[64:65], v[180:181]
    v_pk_mul_f32 v[182:183], v[66:67], v[182:183]
    v_pk_mul_f32 v[184:185], v[72:73], v[184:185]
    v_pk_mul_f32 v[186:187], v[74:75], v[186:187]
    v_exp_f32 v180, v180
    v_exp_f32 v181, v181
    v_pk_mul_f32 v[188:189], v[64:65], v[68:69]
    v_exp_f32 v182, v182
    v_exp_f32 v183, v183
    v_pk_mul_f32 v[190:191], v[66:67], v[70:71]
    v_exp_f32 v184, v184
    v_exp_f32 v185, v185
    v_pk_mul_f32 v[192:193], v[72:73], v[76:77]
    v_exp_f32 v186, v186
    v_exp_f32 v187, v187
    v_pk_mul_f32 v[194:195], v[74:75], v[78:79]
    v_pk_fma_f32 v[180:181], v[180:181], v[178:179], v[178:179] op_sel:[0,0,0] op_sel_hi:[1,0,0]
    v_pk_fma_f32 v[182:183], v[182:183], v[178:179], v[178:179] op_sel:[0,0,0] op_sel_hi:[1,0,0]
    v_pk_fma_f32 v[184:185], v[184:185], v[178:179], v[178:179] op_sel:[0,0,0] op_sel_hi:[1,0,0]
    v_pk_fma_f32 v[186:187], v[186:187], v[178:179], v[178:179] op_sel:[0,0,0] op_sel_hi:[1,0,0]
    v_rcp_f32 v180, v180
    v_rcp_f32 v181, v181
    v_rcp_f32 v182, v182
    v_rcp_f32 v183, v183
    v_rcp_f32 v184, v184
    v_rcp_f32 v185, v185
    v_rcp_f32 v186, v186
    v_rcp_f32 v187, v187
    v_pk_mul_f32 v[188:189], v[188:189], v[180:181]
    v_pk_mul_f32 v[190:191], v[190:191], v[182:183]
    v_pk_mul_f32 v[192:193], v[192:193], v[184:185]
    v_pk_mul_f32 v[194:195], v[194:195], v[186:187]
    v_cvt_pk_bf16_f32 v64, v188, v189
    v_cvt_pk_bf16_f32 v65, v190, v191
    v_cvt_pk_bf16_f32 v66, v192, v193
    v_cvt_pk_bf16_f32 v67, v194, v195
    buffer_store_dwordx4 v[64:67], v22, s[56:59], s91 offen offset:2048 sc1
    v_pk_mul_f32 v[196:197], v[80:81], v[80:81]
    v_pk_mul_f32 v[198:199], v[82:83], v[82:83]
    v_pk_mul_f32 v[200:201], v[88:89], v[88:89]
    v_pk_mul_f32 v[202:203], v[90:91], v[90:91]
    v_pk_fma_f32 v[196:197], v[196:197], v[176:177], v[176:177] op_sel:[0,0,1] op_sel_hi:[1,0,1]
    v_pk_fma_f32 v[198:199], v[198:199], v[176:177], v[176:177] op_sel:[0,0,1] op_sel_hi:[1,0,1]
    v_pk_fma_f32 v[200:201], v[200:201], v[176:177], v[176:177] op_sel:[0,0,1] op_sel_hi:[1,0,1]
    v_pk_fma_f32 v[202:203], v[202:203], v[176:177], v[176:177] op_sel:[0,0,1] op_sel_hi:[1,0,1]
    v_pk_mul_f32 v[196:197], v[80:81], v[196:197]
    v_pk_mul_f32 v[198:199], v[82:83], v[198:199]
    v_pk_mul_f32 v[200:201], v[88:89], v[200:201]
    v_pk_mul_f32 v[202:203], v[90:91], v[202:203]
    v_exp_f32 v196, v196
    v_exp_f32 v197, v197
    v_pk_mul_f32 v[204:205], v[80:81], v[84:85]
    v_exp_f32 v198, v198
    v_exp_f32 v199, v199
    v_pk_mul_f32 v[206:207], v[82:83], v[86:87]
    v_exp_f32 v200, v200
    v_exp_f32 v201, v201
    v_pk_mul_f32 v[208:209], v[88:89], v[92:93]
    v_exp_f32 v202, v202
    v_exp_f32 v203, v203
    v_pk_mul_f32 v[210:211], v[90:91], v[94:95]
    v_pk_fma_f32 v[196:197], v[196:197], v[178:179], v[178:179] op_sel:[0,0,0] op_sel_hi:[1,0,0]
    v_pk_fma_f32 v[198:199], v[198:199], v[178:179], v[178:179] op_sel:[0,0,0] op_sel_hi:[1,0,0]
    v_pk_fma_f32 v[200:201], v[200:201], v[178:179], v[178:179] op_sel:[0,0,0] op_sel_hi:[1,0,0]
    v_pk_fma_f32 v[202:203], v[202:203], v[178:179], v[178:179] op_sel:[0,0,0] op_sel_hi:[1,0,0]
    v_rcp_f32 v196, v196
    v_rcp_f32 v197, v197
    v_rcp_f32 v198, v198
    v_rcp_f32 v199, v199
    v_rcp_f32 v200, v200
    v_rcp_f32 v201, v201
    v_rcp_f32 v202, v202
    v_rcp_f32 v203, v203
    v_pk_mul_f32 v[204:205], v[204:205], v[196:197]
    v_pk_mul_f32 v[206:207], v[206:207], v[198:199]
    v_pk_mul_f32 v[208:209], v[208:209], v[200:201]
    v_pk_mul_f32 v[210:211], v[210:211], v[202:203]
    v_cvt_pk_bf16_f32 v80, v204, v205
    v_cvt_pk_bf16_f32 v81, v206, v207
    v_cvt_pk_bf16_f32 v82, v208, v209
    v_cvt_pk_bf16_f32 v83, v210, v211
    buffer_store_dwordx4 v[80:83], v22, s[56:59], s91 offen offset:3072 sc1
    v_pk_mul_f32 v[180:181], v[96:97], v[96:97]
    v_pk_mul_f32 v[182:183], v[98:99], v[98:99]
    v_pk_mul_f32 v[184:185], v[104:105], v[104:105]
    v_pk_mul_f32 v[186:187], v[106:107], v[106:107]
    v_pk_fma_f32 v[180:181], v[180:181], v[176:177], v[176:177] op_sel:[0,0,1] op_sel_hi:[1,0,1]
    v_pk_fma_f32 v[182:183], v[182:183], v[176:177], v[176:177] op_sel:[0,0,1] op_sel_hi:[1,0,1]
    v_pk_fma_f32 v[184:185], v[184:185], v[176:177], v[176:177] op_sel:[0,0,1] op_sel_hi:[1,0,1]
    v_pk_fma_f32 v[186:187], v[186:187], v[176:177], v[176:177] op_sel:[0,0,1] op_sel_hi:[1,0,1]
    v_pk_mul_f32 v[180:181], v[96:97], v[180:181]
    v_pk_mul_f32 v[182:183], v[98:99], v[182:183]
    v_pk_mul_f32 v[184:185], v[104:105], v[184:185]
    v_pk_mul_f32 v[186:187], v[106:107], v[186:187]
    v_exp_f32 v180, v180
    v_exp_f32 v181, v181
    v_pk_mul_f32 v[188:189], v[96:97], v[100:101]
    v_exp_f32 v182, v182
    v_exp_f32 v183, v183
    v_pk_mul_f32 v[190:191], v[98:99], v[102:103]
    v_exp_f32 v184, v184
    v_exp_f32 v185, v185
    v_pk_mul_f32 v[192:193], v[104:105], v[108:109]
    v_exp_f32 v186, v186
    v_exp_f32 v187, v187
    v_pk_mul_f32 v[194:195], v[106:107], v[110:111]
    v_pk_fma_f32 v[180:181], v[180:181], v[178:179], v[178:179] op_sel:[0,0,0] op_sel_hi:[1,0,0]
    v_pk_fma_f32 v[182:183], v[182:183], v[178:179], v[178:179] op_sel:[0,0,0] op_sel_hi:[1,0,0]
    v_pk_fma_f32 v[184:185], v[184:185], v[178:179], v[178:179] op_sel:[0,0,0] op_sel_hi:[1,0,0]
    v_pk_fma_f32 v[186:187], v[186:187], v[178:179], v[178:179] op_sel:[0,0,0] op_sel_hi:[1,0,0]
    v_rcp_f32 v180, v180
    v_rcp_f32 v181, v181
    v_rcp_f32 v182, v182
    v_rcp_f32 v183, v183
    v_rcp_f32 v184, v184
    v_rcp_f32 v185, v185
    v_rcp_f32 v186, v186
    v_rcp_f32 v187, v187
    v_pk_mul_f32 v[188:189], v[188:189], v[180:181]
    v_pk_mul_f32 v[190:191], v[190:191], v[182:183]
    v_pk_mul_f32 v[192:193], v[192:193], v[184:185]
    v_pk_mul_f32 v[194:195], v[194:195], v[186:187]
    v_cvt_pk_bf16_f32 v96, v188, v189
    v_cvt_pk_bf16_f32 v97, v190, v191
    v_cvt_pk_bf16_f32 v98, v192, v193
    v_cvt_pk_bf16_f32 v99, v194, v195
    s_add_u32 s91, s91, 4096
    buffer_store_dwordx4 v[96:99], v22, s[56:59], s91 offen offset:0 sc1
    v_pk_mul_f32 v[196:197], v[112:113], v[112:113]
    v_pk_mul_f32 v[198:199], v[114:115], v[114:115]
    v_pk_mul_f32 v[200:201], v[120:121], v[120:121]
    v_pk_mul_f32 v[202:203], v[122:123], v[122:123]
    v_pk_fma_f32 v[196:197], v[196:197], v[176:177], v[176:177] op_sel:[0,0,1] op_sel_hi:[1,0,1]
    v_pk_fma_f32 v[198:199], v[198:199], v[176:177], v[176:177] op_sel:[0,0,1] op_sel_hi:[1,0,1]
    v_pk_fma_f32 v[200:201], v[200:201], v[176:177], v[176:177] op_sel:[0,0,1] op_sel_hi:[1,0,1]
    v_pk_fma_f32 v[202:203], v[202:203], v[176:177], v[176:177] op_sel:[0,0,1] op_sel_hi:[1,0,1]
    v_pk_mul_f32 v[196:197], v[112:113], v[196:197]
    v_pk_mul_f32 v[198:199], v[114:115], v[198:199]
    v_pk_mul_f32 v[200:201], v[120:121], v[200:201]
    v_pk_mul_f32 v[202:203], v[122:123], v[202:203]
    v_exp_f32 v196, v196
    v_exp_f32 v197, v197
    v_pk_mul_f32 v[204:205], v[112:113], v[116:117]
    v_exp_f32 v198, v198
    v_exp_f32 v199, v199
    v_pk_mul_f32 v[206:207], v[114:115], v[118:119]
    v_exp_f32 v200, v200
    v_exp_f32 v201, v201
    v_pk_mul_f32 v[208:209], v[120:121], v[124:125]
    v_exp_f32 v202, v202
    v_exp_f32 v203, v203
    v_pk_mul_f32 v[210:211], v[122:123], v[126:127]
    v_pk_fma_f32 v[196:197], v[196:197], v[178:179], v[178:179] op_sel:[0,0,0] op_sel_hi:[1,0,0]
    v_pk_fma_f32 v[198:199], v[198:199], v[178:179], v[178:179] op_sel:[0,0,0] op_sel_hi:[1,0,0]
    v_pk_fma_f32 v[200:201], v[200:201], v[178:179], v[178:179] op_sel:[0,0,0] op_sel_hi:[1,0,0]
    v_pk_fma_f32 v[202:203], v[202:203], v[178:179], v[178:179] op_sel:[0,0,0] op_sel_hi:[1,0,0]
    v_rcp_f32 v196, v196
    v_rcp_f32 v197, v197
    v_rcp_f32 v198, v198
    v_rcp_f32 v199, v199
    v_rcp_f32 v200, v200
    v_rcp_f32 v201, v201
    v_rcp_f32 v202, v202
    v_rcp_f32 v203, v203
    v_pk_mul_f32 v[204:205], v[204:205], v[196:197]
    v_pk_mul_f32 v[206:207], v[206:207], v[198:199]
    v_pk_mul_f32 v[208:209], v[208:209], v[200:201]
    v_pk_mul_f32 v[210:211], v[210:211], v[202:203]
    v_cvt_pk_bf16_f32 v112, v204, v205
    v_cvt_pk_bf16_f32 v113, v206, v207
    v_cvt_pk_bf16_f32 v114, v208, v209
    v_cvt_pk_bf16_f32 v115, v210, v211
    buffer_store_dwordx4 v[112:115], v22, s[56:59], s91 offen offset:1024 sc1
    v_pk_mul_f32 v[180:181], v[128:129], v[128:129]
    v_pk_mul_f32 v[182:183], v[130:131], v[130:131]
    v_pk_mul_f32 v[184:185], v[136:137], v[136:137]
    v_pk_mul_f32 v[186:187], v[138:139], v[138:139]
    v_pk_fma_f32 v[180:181], v[180:181], v[176:177], v[176:177] op_sel:[0,0,1] op_sel_hi:[1,0,1]
    v_pk_fma_f32 v[182:183], v[182:183], v[176:177], v[176:177] op_sel:[0,0,1] op_sel_hi:[1,0,1]
    v_pk_fma_f32 v[184:185], v[184:185], v[176:177], v[176:177] op_sel:[0,0,1] op_sel_hi:[1,0,1]
    v_pk_fma_f32 v[186:187], v[186:187], v[176:177], v[176:177] op_sel:[0,0,1] op_sel_hi:[1,0,1]
    v_pk_mul_f32 v[180:181], v[128:129], v[180:181]
    v_pk_mul_f32 v[182:183], v[130:131], v[182:183]
    v_pk_mul_f32 v[184:185], v[136:137], v[184:185]
    v_pk_mul_f32 v[186:187], v[138:139], v[186:187]
    v_exp_f32 v180, v180
    v_exp_f32 v181, v181
    v_pk_mul_f32 v[188:189], v[128:129], v[132:133]
    v_exp_f32 v182, v182
    v_exp_f32 v183, v183
    v_pk_mul_f32 v[190:191], v[130:131], v[134:135]
    v_exp_f32 v184, v184
    v_exp_f32 v185, v185
    v_pk_mul_f32 v[192:193], v[136:137], v[140:141]
    v_exp_f32 v186, v186
    v_exp_f32 v187, v187
    v_pk_mul_f32 v[194:195], v[138:139], v[142:143]
    v_pk_fma_f32 v[180:181], v[180:181], v[178:179], v[178:179] op_sel:[0,0,0] op_sel_hi:[1,0,0]
    v_pk_fma_f32 v[182:183], v[182:183], v[178:179], v[178:179] op_sel:[0,0,0] op_sel_hi:[1,0,0]
    v_pk_fma_f32 v[184:185], v[184:185], v[178:179], v[178:179] op_sel:[0,0,0] op_sel_hi:[1,0,0]
    v_pk_fma_f32 v[186:187], v[186:187], v[178:179], v[178:179] op_sel:[0,0,0] op_sel_hi:[1,0,0]
    v_rcp_f32 v180, v180
    v_rcp_f32 v181, v181
    v_rcp_f32 v182, v182
    v_rcp_f32 v183, v183
    v_rcp_f32 v184, v184
    v_rcp_f32 v185, v185
    v_rcp_f32 v186, v186
    v_rcp_f32 v187, v187
    v_pk_mul_f32 v[188:189], v[188:189], v[180:181]
    v_pk_mul_f32 v[190:191], v[190:191], v[182:183]
    v_pk_mul_f32 v[192:193], v[192:193], v[184:185]
    v_pk_mul_f32 v[194:195], v[194:195], v[186:187]
    v_cvt_pk_bf16_f32 v128, v188, v189
    v_cvt_pk_bf16_f32 v129, v190, v191
    v_cvt_pk_bf16_f32 v130, v192, v193
    v_cvt_pk_bf16_f32 v131, v194, v195
    buffer_store_dwordx4 v[128:131], v22, s[56:59], s91 offen offset:2048 sc1
    v_accvgpr_read_b32 v178, a52
    v_accvgpr_read_b32 v179, a53
    v_accvgpr_read_b32 v176, a48
    v_accvgpr_read_b32 v177, a49
    v_accvgpr_read_b32 v180, a56
    v_accvgpr_read_b32 v181, a57
    s_waitcnt vmcnt(7)
    v_accvgpr_read_b32 v182, a28
    v_accvgpr_read_b32 v183, a29
    v_accvgpr_read_b32 v206, a26
    v_accvgpr_read_b32 v207, a27
    v_pk_fma_f32 v[184:185], v[178:179], v[182:183], v[206:207] op_sel:[0,0,0] op_sel_hi:[0,1,1]
    v_pk_fma_f32 v[184:185], v[178:179], v[182:183], v[184:185] op_sel:[1,1,0] op_sel_hi:[1,0,1] neg_lo:[1,0,0]
    v_accvgpr_read_b32 v204, a24
    v_accvgpr_read_b32 v205, a25
    v_pk_fma_f32 v[182:183], v[178:179], v[184:185], v[204:205] op_sel:[0,0,0] op_sel_hi:[0,1,1]
    v_pk_fma_f32 v[182:183], v[178:179], v[184:185], v[182:183] op_sel:[1,1,0] op_sel_hi:[1,0,1] neg_lo:[1,0,0]
    v_accvgpr_read_b32 v206, a22
    v_accvgpr_read_b32 v207, a23
    v_pk_fma_f32 v[184:185], v[178:179], v[182:183], v[206:207] op_sel:[0,0,0] op_sel_hi:[0,1,1]
    v_pk_fma_f32 v[184:185], v[178:179], v[182:183], v[184:185] op_sel:[1,1,0] op_sel_hi:[1,0,1] neg_lo:[1,0,0]
    v_accvgpr_read_b32 v204, a20
    v_accvgpr_read_b32 v205, a21
    v_pk_fma_f32 v[182:183], v[178:179], v[184:185], v[204:205] op_sel:[0,0,0] op_sel_hi:[0,1,1]
    v_pk_fma_f32 v[182:183], v[178:179], v[184:185], v[182:183] op_sel:[1,1,0] op_sel_hi:[1,0,1] neg_lo:[1,0,0]
    v_accvgpr_read_b32 v206, a18
    v_accvgpr_read_b32 v207, a19
    v_pk_fma_f32 v[184:185], v[178:179], v[182:183], v[206:207] op_sel:[0,0,0] op_sel_hi:[0,1,1]
    v_pk_fma_f32 v[184:185], v[178:179], v[182:183], v[184:185] op_sel:[1,1,0] op_sel_hi:[1,0,1] neg_lo:[1,0,0]
    v_accvgpr_read_b32 v204, a16
    v_accvgpr_read_b32 v205, a17
    v_pk_fma_f32 v[182:183], v[178:179], v[184:185], v[204:205] op_sel:[0,0,0] op_sel_hi:[0,1,1]
    v_pk_fma_f32 v[182:183], v[178:179], v[184:185], v[182:183] op_sel:[1,1,0] op_sel_hi:[1,0,1] neg_lo:[1,0,0]
    v_accvgpr_read_b32 v206, a14
    v_accvgpr_read_b32 v207, a15
    v_pk_fma_f32 v[184:185], v[178:179], v[182:183], v[206:207] op_sel:[0,0,0] op_sel_hi:[0,1,1]
    v_pk_fma_f32 v[184:185], v[178:179], v[182:183], v[184:185] op_sel:[1,1,0] op_sel_hi:[1,0,1] neg_lo:[1,0,0]
    v_accvgpr_read_b32 v204, a12
    v_accvgpr_read_b32 v205, a13
    v_pk_fma_f32 v[182:183], v[178:179], v[184:185], v[204:205] op_sel:[0,0,0] op_sel_hi:[0,1,1]
    v_pk_fma_f32 v[182:183], v[178:179], v[184:185], v[182:183] op_sel:[1,1,0] op_sel_hi:[1,0,1] neg_lo:[1,0,0]
    v_accvgpr_read_b32 v206, a10
    v_accvgpr_read_b32 v207, a11
    v_pk_fma_f32 v[184:185], v[178:179], v[182:183], v[206:207] op_sel:[0,0,0] op_sel_hi:[0,1,1]
    v_pk_fma_f32 v[184:185], v[178:179], v[182:183], v[184:185] op_sel:[1,1,0] op_sel_hi:[1,0,1] neg_lo:[1,0,0]
    v_accvgpr_read_b32 v204, a8
    v_accvgpr_read_b32 v205, a9
    v_pk_fma_f32 v[182:183], v[178:179], v[184:185], v[204:205] op_sel:[0,0,0] op_sel_hi:[0,1,1]
    v_pk_fma_f32 v[182:183], v[178:179], v[184:185], v[182:183] op_sel:[1,1,0] op_sel_hi:[1,0,1] neg_lo:[1,0,0]
    v_accvgpr_read_b32 v206, a6
    v_accvgpr_read_b32 v207, a7
    v_pk_fma_f32 v[184:185], v[178:179], v[182:183], v[206:207] op_sel:[0,0,0] op_sel_hi:[0,1,1]
    v_pk_fma_f32 v[184:185], v[178:179], v[182:183], v[184:185] op_sel:[1,1,0] op_sel_hi:[1,0,1] neg_lo:[1,0,0]
    v_accvgpr_read_b32 v204, a4
    v_accvgpr_read_b32 v205, a5
    v_pk_fma_f32 v[182:183], v[178:179], v[184:185], v[204:205] op_sel:[0,0,0] op_sel_hi:[0,1,1]
    v_pk_fma_f32 v[182:183], v[178:179], v[184:185], v[182:183] op_sel:[1,1,0] op_sel_hi:[1,0,1] neg_lo:[1,0,0]
    v_accvgpr_read_b32 v206, a2
    v_accvgpr_read_b32 v207, a3
    v_pk_fma_f32 v[184:185], v[178:179], v[182:183], v[206:207] op_sel:[0,0,0] op_sel_hi:[0,1,1]
    v_pk_fma_f32 v[184:185], v[178:179], v[182:183], v[184:185] op_sel:[1,1,0] op_sel_hi:[1,0,1] neg_lo:[1,0,0]
    v_accvgpr_read_b32 v204, a0
    v_accvgpr_read_b32 v205, a1
    v_pk_fma_f32 v[182:183], v[178:179], v[184:185], v[204:205] op_sel:[0,0,0] op_sel_hi:[0,1,1]
    v_pk_fma_f32 v[182:183], v[178:179], v[184:185], v[182:183] op_sel:[1,1,0] op_sel_hi:[1,0,1] neg_lo:[1,0,0]
    v_cmp_u_f32 vcc, v182, v182
    s_nop 3
    s_cmp_eq_u64 vcc, 0
    s_cbranch_scc0 L_slow_e
L_back_e:
    v_accvgpr_read_b32 v178, a54
    v_accvgpr_read_b32 v179, a55
    v_accvgpr_read_b32 v186, a58
    v_accvgpr_read_b32 v187, a59
    v_pk_fma_f32 v[188:189], v[178:179], v[182:183], v[186:187] op_sel:[0,0,0] op_sel_hi:[0,1,1]
    v_pk_fma_f32 v[188:189], v[178:179], v[182:183], v[188:189] op_sel:[1,1,0] op_sel_hi:[1,0,1] neg_lo:[1,0,0]
    v_accvgpr_read_b32 v178, a60
    v_accvgpr_read_b32 v179, a61
    v_accvgpr_read_b32 v186, a50
    v_accvgpr_read_b32 v187, a51
    v_pk_fma_f32 v[190:191], v[178:179], v[188:189], v[186:187] op_sel:[0,0,0] op_sel_hi:[0,1,1]
    v_pk_fma_f32 v[190:191], v[178:179], v[188:189], v[190:191] op_sel:[1,1,0] op_sel_hi:[1,0,1] neg_lo:[1,0,0]
    v_mov_b32 v192, v188
    v_mov_b32 v193, v190
    v_mov_b32 v194, v189
    v_mov_b32 v195, v191
    v_pk_fma_f32 v[196:197], v[176:177], v[192:193], v[144:145] op_sel:[0,0,0] op_sel_hi:[0,1,1]
    v_pk_fma_f32 v[198:199], v[176:177], v[194:195], v[160:161] op_sel:[0,0,0] op_sel_hi:[0,1,1]
    v_pk_fma_f32 v[196:197], v[176:177], v[194:195], v[196:197] op_sel:[1,0,0] op_sel_hi:[1,1,1] neg_lo:[1,0,0] neg_hi:[1,0,0]
    v_pk_fma_f32 v[198:199], v[176:177], v[192:193], v[198:199] op_sel:[1,0,0] op_sel_hi:[1,1,1]
    v_pk_mul_f32 v[200:201], v[180:181], v[196:197] op_sel:[0,0] op_sel_hi:[0,1]
    v_pk_mul_f32 v[202:203], v[180:181], v[198:199] op_sel:[0,0] op_sel_hi:[0,1]
    v_pk_fma_f32 v[200:201], v[180:181], v[198:199], v[200:201] op_sel:[1,0,0] op_sel_hi:[1,1,1] neg_lo:[1,0,0] neg_hi:[1,0,0]
    v_pk_fma_f32 v[202:203], v[180:181], v[196:197], v[202:203] op_sel:[1,0,0] op_sel_hi:[1,1,1]
    v_pk_mul_f32 v[200:201], v[2:3], v[200:201]
    v_pk_mul_f32 v[202:203], v[2:3], v[202:203] neg_lo:[1,0] neg_hi:[1,0]
    v_cvt_pk_bf16_f32 v214, v200, v201
    v_cvt_pk_bf16_f32 v222, v202, v203
    v_pk_fma_f32 v[192:193], v[176:177], v[196:197], v[146:147] op_sel:[0,0,0] op_sel_hi:[0,1,1]
    v_pk_fma_f32 v[194:195], v[176:177], v[198:199], v[162:163] op_sel:[0,0,0] op_sel_hi:[0,1,1]
    v_pk_fma_f32 v[192:193], v[176:177], v[198:199], v[192:193] op_sel:[1,0,0] op_sel_hi:[1,1,1] neg_lo:[1,0,0] neg_hi:[1,0,0]
    v_pk_fma_f32 v[194:195], v[176:177], v[196:197], v[194:195] op_sel:[1,0,0] op_sel_hi:[1,1,1]
    v_pk_mul_f32 v[200:201], v[180:181], v[192:193] op_sel:[0,0] op_sel_hi:[0,1]
    v_pk_mul_f32 v[202:203], v[180:181], v[194:195] op_sel:[0,0] op_sel_hi:[0,1]
    v_pk_fma_f32 v[200:201], v[180:181], v[194:195], v[200:201] op_sel:[1,0,0] op_sel_hi:[1,1,1] neg_lo:[1,0,0] neg_hi:[1,0,0]
    v_pk_fma_f32 v[202:203], v[180:181], v[192:193], v[202:203] op_sel:[1,0,0] op_sel_hi:[1,1,1]
    v_pk_mul_f32 v[200:201], v[4:5], v[200:201]
    v_pk_mul_f32 v[202:203], v[4:5], v[202:203] neg_lo:[1,0] neg_hi:[1,0]
    v_cvt_pk_bf16_f32 v215, v200, v201
    v_cvt_pk_bf16_f32 v223, v202, v203
    v_pk_fma_f32 v[196:197], v[176:177], v[192:193], v[148:149] op_sel:[0,0,0] op_sel_hi:[0,1,1]
    v_pk_fma_f32 v[198:199], v[176:177], v[194:195], v[164:165] op_sel:[0,0,0] op_sel_hi:[0,1,1]
    v_pk_fma_f32 v[196:197], v[176:177], v[194:195], v[196:197] op_sel:[1,0,0] op_sel_hi:[1,1,1] neg_lo:[1,0,0] neg_hi:[1,0,0]
    v_pk_fma_f32 v[198:199], v[176:177], v[192:193], v[198:199] op_sel:[1,0,0] op_sel_hi:[1,1,1]
    v_pk_mul_f32 v[200:201], v[180:181], v[196:197] op_sel:[0,0] op_sel_hi:[0,1]
    v_pk_mul_f32 v[202:203], v[180:181], v[198:199] op_sel:[0,0] op_sel_hi:[0,1]
    v_pk_fma_f32 v[200:201], v[180:181], v[198:199], v[200:201] op_sel:[1,0,0] op_sel_hi:[1,1,1] neg_lo:[1,0,0] neg_hi:[1,0,0]
    v_pk_fma_f32 v[202:203], v[180:181], v[196:197], v[202:203] op_sel:[1,0,0] op_sel_hi:[1,1,1]
    v_pk_mul_f32 v[200:201], v[6:7], v[200:201]
    v_pk_mul_f32 v[202:203], v[6:7], v[202:203] neg_lo:[1,0] neg_hi:[1,0]
    v_cvt_pk_bf16_f32 v216, v200, v201
    v_cvt_pk_bf16_f32 v224, v202, v203
    v_pk_fma_f32 v[192:193], v[176:177], v[196:197], v[150:151] op_sel:[0,0,0] op_sel_hi:[0,1,1]
    v_pk_fma_f32 v[194:195], v[176:177], v[198:199], v[166:167] op_sel:[0,0,0] op_sel_hi:[0,1,1]
    v_pk_fma_f32 v[192:193], v[176:177], v[198:199], v[192:193] op_sel:[1,0,0] op_sel_hi:[1,1,1] neg_lo:[1,0,0] neg_hi:[1,0,0]
    v_pk_fma_f32 v[194:195], v[176:177], v[196:197], v[194:195] op_sel:[1,0,0] op_sel_hi:[1,1,1]
    v_pk_mul_f32 v[200:201], v[180:181], v[192:193] op_sel:[0,0] op_sel_hi:[0,1]
    v_pk_mul_f32 v[202:203], v[180:181], v[194:195] op_sel:[0,0] op_sel_hi:[0,1]
    v_pk_fma_f32 v[200:201], v[180:181], v[194:195], v[200:201] op_sel:[1,0,0] op_sel_hi:[1,1,1] neg_lo:[1,0,0] neg_hi:[1,0,0]
    v_pk_fma_f32 v[202:203], v[180:181], v[192:193], v[202:203] op_sel:[1,0,0] op_sel_hi:[1,1,1]
    v_pk_mul_f32 v[200:201], v[8:9], v[200:201]
    v_pk_mul_f32 v[202:203], v[8:9], v[202:203] neg_lo:[1,0] neg_hi:[1,0]
    v_cvt_pk_bf16_f32 v217, v200, v201
    v_cvt_pk_bf16_f32 v225, v202, v203
    v_pk_fma_f32 v[196:197], v[176:177], v[192:193], v[152:153] op_sel:[0,0,0] op_sel_hi:[0,1,1]
    v_pk_fma_f32 v[198:199], v[176:177], v[194:195], v[168:169] op_sel:[0,0,0] op_sel_hi:[0,1,1]
    v_pk_fma_f32 v[196:197], v[176:177], v[194:195], v[196:197] op_sel:[1,0,0] op_sel_hi:[1,1,1] neg_lo:[1,0,0] neg_hi:[1,0,0]
    v_pk_fma_f32 v[198:199], v[176:177], v[192:193], v[198:199] op_sel:[1,0,0] op_sel_hi:[1,1,1]
    v_pk_mul_f32 v[200:201], v[180:181], v[196:197] op_sel:[0,0] op_sel_hi:[0,1]
    v_pk_mul_f32 v[202:203], v[180:181], v[198:199] op_sel:[0,0] op_sel_hi:[0,1]
    v_pk_fma_f32 v[200:201], v[180:181], v[198:199], v[200:201] op_sel:[1,0,0] op_sel_hi:[1,1,1] neg_lo:[1,0,0] neg_hi:[1,0,0]
    v_pk_fma_f32 v[202:203], v[180:181], v[196:197], v[202:203] op_sel:[1,0,0] op_sel_hi:[1,1,1]
    v_pk_mul_f32 v[200:201], v[10:11], v[200:201]
    v_pk_mul_f32 v[202:203], v[10:11], v[202:203] neg_lo:[1,0] neg_hi:[1,0]
    v_cvt_pk_bf16_f32 v218, v200, v201
    v_cvt_pk_bf16_f32 v226, v202, v203
    v_pk_fma_f32 v[192:193], v[176:177], v[196:197], v[154:155] op_sel:[0,0,0] op_sel_hi:[0,1,1]
    v_pk_fma_f32 v[194:195], v[176:177], v[198:199], v[170:171] op_sel:[0,0,0] op_sel_hi:[0,1,1]
    v_pk_fma_f32 v[192:193], v[176:177], v[198:199], v[192:193] op_sel:[1,0,0] op_sel_hi:[1,1,1] neg_lo:[1,0,0] neg_hi:[1,0,0]
    v_pk_fma_f32 v[194:195], v[176:177], v[196:197], v[194:195] op_sel:[1,0,0] op_sel_hi:[1,1,1]
    v_pk_mul_f32 v[200:201], v[180:181], v[192:193] op_sel:[0,0] op_sel_hi:[0,1]
    v_pk_mul_f32 v[202:203], v[180:181], v[194:195] op_sel:[0,0] op_sel_hi:[0,1]
    v_pk_fma_f32 v[200:201], v[180:181], v[194:195], v[200:201] op_sel:[1,0,0] op_sel_hi:[1,1,1] neg_lo:[1,0,0] neg_hi:[1,0,0]
    v_pk_fma_f32 v[202:203], v[180:181], v[192:193], v[202:203] op_sel:[1,0,0] op_sel_hi:[1,1,1]
    v_pk_mul_f32 v[200:201], v[12:13], v[200:201]
    v_pk_mul_f32 v[202:203], v[12:13], v[202:203] neg_lo:[1,0] neg_hi:[1,0]
    v_cvt_pk_bf16_f32 v219, v200, v201
    v_cvt_pk_bf16_f32 v227, v202, v203
    v_pk_fma_f32 v[196:197], v[176:177], v[192:193], v[156:157] op_sel:[0,0,0] op_sel_hi:[0,1,1]
    v_pk_fma_f32 v[198:199], v[176:177], v[194:195], v[172:173] op_sel:[0,0,0] op_sel_hi:[0,1,1]
    v_pk_fma_f32 v[196:197], v[176:177], v[194:195], v[196:197] op_sel:[1,0,0] op_sel_hi:[1,1,1] neg_lo:[1,0,0] neg_hi:[1,0,0]
    v_pk_fma_f32 v[198:199], v[176:177], v[192:193], v[198:199] op_sel:[1,0,0] op_sel_hi:[1,1,1]
    v_pk_mul_f32 v[200:201], v[180:181], v[196:197] op_sel:[0,0] op_sel_hi:[0,1]
    v_pk_mul_f32 v[202:203], v[180:181], v[198:199] op_sel:[0,0] op_sel_hi:[0,1]
    v_pk_fma_f32 v[200:201], v[180:181], v[198:199], v[200:201] op_sel:[1,0,0] op_sel_hi:[1,1,1] neg_lo:[1,0,0] neg_hi:[1,0,0]
    v_pk_fma_f32 v[202:203], v[180:181], v[196:197], v[202:203] op_sel:[1,0,0] op_sel_hi:[1,1,1]
    v_pk_mul_f32 v[200:201], v[18:19], v[200:201]
    v_pk_mul_f32 v[202:203], v[18:19], v[202:203] neg_lo:[1,0] neg_hi:[1,0]
    v_cvt_pk_bf16_f32 v220, v200, v201
    v_cvt_pk_bf16_f32 v228, v202, v203
    v_pk_fma_f32 v[192:193], v[176:177], v[196:197], v[158:159] op_sel:[0,0,0] op_sel_hi:[0,1,1]
    v_pk_fma_f32 v[194:195], v[176:177], v[198:199], v[174:175] op_sel:[0,0,0] op_sel_hi:[0,1,1]
    v_pk_fma_f32 v[192:193], v[176:177], v[198:199], v[192:193] op_sel:[1,0,0] op_sel_hi:[1,1,1] neg_lo:[1,0,0] neg_hi:[1,0,0]
    v_pk_fma_f32 v[194:195], v[176:177], v[196:197], v[194:195] op_sel:[1,0,0] op_sel_hi:[1,1,1]
    v_pk_mul_f32 v[200:201], v[180:181], v[192:193] op_sel:[0,0] op_sel_hi:[0,1]
    v_pk_mul_f32 v[202:203], v[180:181], v[194:195] op_sel:[0,0] op_sel_hi:[0,1]
    v_pk_fma_f32 v[200:201], v[180:181], v[194:195], v[200:201] op_sel:[1,0,0] op_sel_hi:[1,1,1] neg_lo:[1,0,0] neg_hi:[1,0,0]
    v_pk_fma_f32 v[202:203], v[180:181], v[192:193], v[202:203] op_sel:[1,0,0] op_sel_hi:[1,1,1]
    v_pk_mul_f32 v[200:201], v[20:21], v[200:201]
    v_pk_mul_f32 v[202:203], v[20:21], v[202:203] neg_lo:[1,0] neg_hi:[1,0]
    v_cvt_pk_bf16_f32 v221, v200, v201
    v_cvt_pk_bf16_f32 v229, v202, v203
    v_accvgpr_read_b32 v204, a188
    v_accvgpr_read_b32 v205, a189
    v_accvgpr_read_b32 v206, a190
    v_accvgpr_read_b32 v207, a191
    ds_write_b128 v204, v[214:217] offset:0
    ds_write_b128 v205, v[218:221] offset:0
    ds_write_b128 v204, v[222:225] offset:2048
    ds_write_b128 v205, v[226:229] offset:2048
    s_waitcnt lgkmcnt(0)
    ds_read_b64_tr_b16 v[144:145], v206 offset:0
    ds_read_b64_tr_b16 v[146:147], v207 offset:0
    ds_read_b64_tr_b16 v[148:149], v206 offset:1024
    ds_read_b64_tr_b16 v[150:151], v207 offset:1024
    ds_read_b64_tr_b16 v[152:153], v206 offset:2048
    ds_read_b64_tr_b16 v[154:155], v207 offset:2048
    ds_read_b64_tr_b16 v[156:157], v206 offset:3072
    ds_read_b64_tr_b16 v[158:159], v207 offset:3072
    s_add_u32 s91, s91, 3072
    s_waitcnt lgkmcnt(6)
    buffer_store_dwordx4 v[144:147], v22, s[56:59], s91 offen offset:0 sc1
    s_waitcnt lgkmcnt(4)
    buffer_store_dwordx4 v[148:151], v22, s[56:59], s91 offen offset:1024 sc1
    s_waitcnt lgkmcnt(2)
    buffer_store_dwordx4 v[152:155], v22, s[56:59], s91 offen offset:2048 sc1
    s_waitcnt lgkmcnt(0)
    buffer_store_dwordx4 v[156:159], v22, s[56:59], s91 offen offset:3072 sc1
    s_add_u32 m0, s92, 0
    s_add_u32 s3, s93, 0
    buffer_load_dwordx4 v232, s[64:67], s3 offen offset:0 lds
    buffer_load_dwordx4 v233, s[64:67], s3 offen offset:1024 lds
    s_add_u32 m0, s92, 2048
    s_add_u32 s3, s93, 16384
    buffer_load_dwordx4 v232, s[64:67], s3 offen offset:0 lds
    buffer_load_dwordx4 v233, s[64:67], s3 offen offset:1024 lds
    s_add_u32 m0, s92, 4096
    s_add_u32 s3, s93, 32768
    buffer_load_dwordx4 v232, s[64:67], s3 offen offset:0 lds
    buffer_load_dwordx4 v233, s[64:67], s3 offen offset:1024 lds
    s_add_u32 m0, s92, 6144
    s_add_u32 s3, s93, 49152
    buffer_load_dwordx4 v232, s[64:67], s3 offen offset:0 lds
    buffer_load_dwordx4 v233, s[64:67], s3 offen offset:1024 lds
    s_add_u32 m0, s92, 8192
    s_add_u32 s3, s93, 65536
    buffer_load_dwordx4 v232, s[64:67], s3 offen offset:0 lds
    buffer_load_dwordx4 v233, s[64:67], s3 offen offset:1024 lds
    s_add_u32 m0, s92, 10240
    s_add_u32 s3, s93, 81920
    buffer_load_dwordx4 v232, s[64:67], s3 offen offset:0 lds
    buffer_load_dwordx4 v233, s[64:67], s3 offen offset:1024 lds
    s_add_u32 m0, s92, 12288
    s_add_u32 s3, s93, 98304
    buffer_load_dwordx4 v232, s[64:67], s3 offen offset:0 lds
    buffer_load_dwordx4 v233, s[64:67], s3 offen offset:1024 lds
    s_add_u32 m0, s92, 14336
    s_add_u32 s3, s93, 114688
    buffer_load_dwordx4 v232, s[64:67], s3 offen offset:0 lds
    buffer_load_dwordx4 v233, s[64:67], s3 offen offset:1024 lds
    s_add_u32 m0, s92, 16384
    s_add_u32 s3, s93, 131072
    buffer_load_dwordx4 v232, s[64:67], s3 offen offset:0 lds
    buffer_load_dwordx4 v233, s[64:67], s3 offen offset:1024 lds
    s_waitcnt vmcnt(18)
    s_barrier
    s_lshl_b32 s81, s38, 7
    s_add_u32 s81, s81, 11632644
    s_lshr_b32 s89, s39, 2
    s_lshl_b32 s89, s89, 3
    s_lshl_b32 s89, 1, s89
    s_cmp_eq_u32 s40, 0
    s_cselect_b32 s81, s81, 2146435072
    v_mov_b32 v254, 2146435072
    v_mov_b32 v255, s81
    v_cmp_eq_u32 vcc, 0, v1
    s_nop 1
    v_cndmask_b32 v254, v254, v255, vcc
    v_mov_b32 v255, s89
    buffer_atomic_add v255, v254, s[56:59], 0 offen sc1
    s_lshl_b32 s81, s38, 7
    s_add_u32 s81, s81, 11632640
    s_lshr_b32 s89, s39, 2
    s_lshl_b32 s89, s89, 3
    s_lshl_b32 s89, 1, s89
    s_cmp_eq_u32 s40, 0
    s_cselect_b32 s81, s81, 2146435072
    v_mov_b32 v254, 2146435072
    v_mov_b32 v255, s81
    v_cmp_eq_u32 vcc, 0, v1
    s_nop 1
    v_cndmask_b32 v254, v254, v255, vcc
    v_mov_b32 v255, s89
    buffer_atomic_add v255, v254, s[56:59], 0 offen sc1
    s_add_u32 m0, s92, 18432
    s_add_u32 s3, s93, 147456
    buffer_load_dwordx4 v232, s[64:67], s3 offen offset:0 lds
    buffer_load_dwordx4 v233, s[64:67], s3 offen offset:1024 lds
    s_add_u32 m0, s92, 20480
    s_add_u32 s3, s93, 163840
    buffer_load_dwordx4 v232, s[64:67], s3 offen offset:0 lds
    buffer_load_dwordx4 v233, s[64:67], s3 offen offset:1024 lds
    s_add_u32 m0, s92, 22528
    s_add_u32 s3, s93, 180224
    buffer_load_dwordx4 v232, s[64:67], s3 offen offset:0 lds
    buffer_load_dwordx4 v233, s[64:67], s3 offen offset:1024 lds
    s_add_u32 m0, s92, 24576
    s_add_u32 s3, s93, 196608
    buffer_load_dwordx4 v232, s[64:67], s3 offen offset:0 lds
    buffer_load_dwordx4 v233, s[64:67], s3 offen offset:1024 lds
    s_add_u32 m0, s92, 26624
    s_add_u32 s3, s93, 212992
    buffer_load_dwordx4 v232, s[64:67], s3 offen offset:0 lds
    buffer_load_dwordx4 v233, s[64:67], s3 offen offset:1024 lds
    s_add_u32 m0, s92, 28672
    s_add_u32 s3, s93, 229376
    buffer_load_dwordx4 v232, s[64:67], s3 offen offset:0 lds
    buffer_load_dwordx4 v233, s[64:67], s3 offen offset:1024 lds
    s_add_u32 m0, s92, 30720
    s_add_u32 s3, s93, 245760
    buffer_load_dwordx4 v232, s[64:67], s3 offen offset:0 lds
    buffer_load_dwordx4 v233, s[64:67], s3 offen offset:1024 lds
    s_add_u32 m0, s92, 32768
    s_add_u32 s3, s93, 262144
    buffer_load_dwordx4 v232, s[64:67], s3 offen offset:0 lds
    buffer_load_dwordx4 v233, s[64:67], s3 offen offset:1024 lds
    s_add_u32 m0, s92, 34816
    s_add_u32 s3, s93, 278528
    buffer_load_dwordx4 v232, s[64:67], s3 offen offset:0 lds
    buffer_load_dwordx4 v233, s[64:67], s3 offen offset:1024 lds
    s_add_u32 m0, s92, 36864
    s_add_u32 s3, s93, 294912
    buffer_load_dwordx4 v232, s[64:67], s3 offen offset:0 lds
    buffer_load_dwordx4 v233, s[64:67], s3 offen offset:1024 lds
    s_add_u32 m0, s92, 38912
    s_add_u32 s3, s93, 311296
    buffer_load_dwordx4 v232, s[64:67], s3 offen offset:0 lds
    buffer_load_dwordx4 v233, s[64:67], s3 offen offset:1024 lds
    s_lshl_b32 s81, s41, 7
    s_add_u32 s81, s81, 11632640
    v_mov_b32 v31, 2146435072
    v_mov_b32 v255, s81
    v_cmp_eq_u32 vcc, 0, v1
    s_nop 1
    v_cndmask_b32 v31, v31, v255, vcc
    buffer_load_dword v30, v31, s[56:59], 0 offen sc1
    s_lshl_b32 s96, s41, 2
    s_lshl_b32 s81, s42, 1
    s_add_u32 s96, s96, s81
    s_mul_i32 s96, s96, 176
    s_mul_i32 s81, s40, 44
    s_add_u32 s96, s96, s81
    s_lshl_b32 s96, s96, 10
    s_lshr_b32 s81, s40, 1
    s_mul_i32 s81, s81, 180224
    s_xor_b32 s82, s81, 180224
    s_add_u32 s97, s96, s82
    s_add_u32 s96, s96, s81
    s_waitcnt vmcnt(35)
    ds_read_b64_tr_b16 a[64:65], v238 offset:0
    ds_read_b64_tr_b16 a[66:67], v238 offset:1024
    ds_read_b64_tr_b16 a[68:69], v239 offset:0
    ds_read_b64_tr_b16 a[70:71], v239 offset:1024
    ds_read_b64_tr_b16 a[72:73], v238 offset:2048
    ds_read_b64_tr_b16 a[74:75], v238 offset:3072
    ds_read_b64_tr_b16 a[76:77], v239 offset:2048
    ds_read_b64_tr_b16 a[78:79], v239 offset:3072
    ds_read_b64_tr_b16 a[80:81], v238 offset:4096
    ds_read_b64_tr_b16 a[82:83], v238 offset:5120
    ds_read_b64_tr_b16 a[84:85], v239 offset:4096
    ds_read_b64_tr_b16 a[86:87], v239 offset:5120
    ds_read_b64_tr_b16 a[88:89], v238 offset:6144
    ds_read_b64_tr_b16 a[90:91], v238 offset:7168
    ds_read_b64_tr_b16 a[92:93], v239 offset:6144
    ds_read_b64_tr_b16 a[94:95], v239 offset:7168
    s_waitcnt lgkmcnt(0)
    s_add_u32 m0, s92, 0
    s_add_u32 s3, s93, 327680
    buffer_load_dwordx4 v232, s[64:67], s3 offen offset:0 lds
    buffer_load_dwordx4 v233, s[64:67], s3 offen offset:1024 lds
    s_add_u32 m0, s92, 2048
    s_add_u32 s3, s93, 344064
    buffer_load_dwordx4 v232, s[64:67], s3 offen offset:0 lds
    buffer_load_dwordx4 v233, s[64:67], s3 offen offset:1024 lds
    s_add_u32 m0, s92, 4096
    s_add_u32 s3, s93, 360448
    buffer_load_dwordx4 v232, s[64:67], s3 offen offset:0 lds
    buffer_load_dwordx4 v233, s[64:67], s3 offen offset:1024 lds
    s_add_u32 m0, s92, 6144
    s_add_u32 s3, s93, 376832
    buffer_load_dwordx4 v232, s[64:67], s3 offen offset:0 lds
    buffer_load_dwordx4 v233, s[64:67], s3 offen offset:1024 lds
    s_waitcnt vmcnt(35)
    ds_read_b64_tr_b16 a[96:97], v238 offset:8192
    ds_read_b64_tr_b16 a[98:99], v238 offset:9216
    ds_read_b64_tr_b16 a[100:101], v239 offset:8192
    ds_read_b64_tr_b16 a[102:103], v239 offset:9216
    ds_read_b64_tr_b16 a[104:105], v238 offset:10240
    ds_read_b64_tr_b16 a[106:107], v238 offset:11264
    ds_read_b64_tr_b16 a[108:109], v239 offset:10240
    ds_read_b64_tr_b16 a[110:111], v239 offset:11264
    ds_read_b64_tr_b16 a[112:113], v238 offset:12288
    ds_read_b64_tr_b16 a[114:115], v238 offset:13312
    ds_read_b64_tr_b16 a[116:117], v239 offset:12288
    ds_read_b64_tr_b16 a[118:119], v239 offset:13312
    ds_read_b64_tr_b16 a[120:121], v238 offset:14336
    ds_read_b64_tr_b16 a[122:123], v238 offset:15360
    ds_read_b64_tr_b16 a[124:125], v239 offset:14336
    ds_read_b64_tr_b16 a[126:127], v239 offset:15360
    s_waitcnt lgkmcnt(0)
    s_add_u32 m0, s92, 8192
    s_add_u32 s3, s94, 128
    buffer_load_dwordx4 v234, s[48:51], s3 offen offset:0 lds
    buffer_load_dwordx4 v235, s[48:51], s3 offen offset:1024 lds
    buffer_load_dwordx4 v236, s[48:51], s3 offen offset:2048 lds
    buffer_load_dwordx4 v237, s[48:51], s3 offen offset:3072 lds
    s_add_u32 m0, s92, 12288
    s_add_u32 s3, s90, 128
    buffer_load_dwordx4 v234, s[48:51], s3 offen offset:0 lds
    buffer_load_dwordx4 v235, s[48:51], s3 offen offset:1024 lds
    buffer_load_dwordx4 v236, s[48:51], s3 offen offset:2048 lds
    buffer_load_dwordx4 v237, s[48:51], s3 offen offset:3072 lds
    s_waitcnt vmcnt(16)
    v_readlane_b32 s81, v30, 0
    s_lshl_b32 s82, s40, 3
    s_lshr_b32 s81, s81, s82
    s_and_b32 s81, s81, 0xff
    s_cmp_eq_u32 s81, 4
    s_cbranch_scc0 L_slow_a
L_back_a:
    s_add_u32 s83, s96, 0
    buffer_load_dwordx4 v[96:99], v22, s[56:59], s83 offen sc1
    s_add_u32 s84, s97, 0
    buffer_load_dwordx4 v[100:103], v22, s[56:59], s84 offen sc1
    s_add_u32 s83, s96, 1024
    buffer_load_dwordx4 v[104:107], v22, s[56:59], s83 offen sc1
    s_add_u32 s84, s97, 1024
    buffer_load_dwordx4 v[108:111], v22, s[56:59], s84 offen sc1
    s_add_u32 s83, s96, 2048
    buffer_load_dwordx4 v[112:115], v22, s[56:59], s83 offen sc1
    s_add_u32 s84, s97, 2048
    buffer_load_dwordx4 v[116:119], v22, s[56:59], s84 offen sc1
    s_add_u32 s83, s96, 3072
    buffer_load_dwordx4 v[120:123], v22, s[56:59], s83 offen sc1
    s_add_u32 s84, s97, 3072
    buffer_load_dwordx4 v[124:127], v22, s[56:59], s84 offen sc1
    s_add_u32 s83, s96, 4096
    buffer_load_dwordx4 v[128:131], v22, s[56:59], s83 offen sc1
    s_add_u32 s84, s97, 4096
    buffer_load_dwordx4 v[132:135], v22, s[56:59], s84 offen sc1
    s_waitcnt vmcnt(9)
    v_mfma_f32_32x32x16_bf16 v[32:47], v[96:99], a[64:67], 0
    ds_read_b64_tr_b16 a[128:129], v238 offset:16384
    ds_read_b64_tr_b16 a[130:131], v238 offset:17408
    v_mfma_f32_32x32x16_bf16 v[48:63], v[96:99], a[68:71], 0
    ds_read_b64_tr_b16 a[132:133], v239 offset:16384
    ds_read_b64_tr_b16 a[134:135], v239 offset:17408
    ds_read_b64_tr_b16 a[136:137], v238 offset:18432
    s_waitcnt vmcnt(8)
    v_mfma_f32_32x32x16_bf16 v[64:79], v[100:103], a[64:67], 0
    ds_read_b64_tr_b16 a[138:139], v238 offset:19456
    ds_read_b64_tr_b16 a[140:141], v239 offset:18432
    ds_read_b64_tr_b16 a[142:143], v239 offset:19456
    ds_read_b64_tr_b16 a[144:145], v238 offset:20480
    v_mfma_f32_32x32x16_bf16 v[80:95], v[100:103], a[68:71], 0
    s_add_u32 s83, s96, 5120
    buffer_load_dwordx4 v[136:139], v22, s[56:59], s83 offen sc1
    s_add_u32 s84, s97, 5120
    buffer_load_dwordx4 v[140:143], v22, s[56:59], s84 offen sc1
    s_add_u32 s83, s96, 6144
    buffer_load_dwordx4 v[144:147], v22, s[56:59], s83 offen sc1
    s_add_u32 s84, s97, 6144
    buffer_load_dwordx4 v[148:151], v22, s[56:59], s84 offen sc1
    s_waitcnt vmcnt(11)
    v_mfma_f32_32x32x16_bf16 v[32:47], v[104:107], a[72:75], v[32:47]
    ds_read_b64_tr_b16 a[146:147], v238 offset:21504
    ds_read_b64_tr_b16 a[148:149], v239 offset:20480
    ds_read_b64_tr_b16 a[150:151], v239 offset:21504
    v_mfma_f32_32x32x16_bf16 v[48:63], v[104:107], a[76:79], v[48:63]
    ds_read_b64_tr_b16 a[152:153], v238 offset:22528
    ds_read_b64_tr_b16 a[154:155], v238 offset:23552
    ds_read_b64_tr_b16 a[156:157], v239 offset:22528
    s_waitcnt vmcnt(10)
    v_mfma_f32_32x32x16_bf16 v[64:79], v[108:111], a[72:75], v[64:79]
    ds_read_b64_tr_b16 a[158:159], v239 offset:23552
    s_waitcnt lgkmcnt(0)
    s_add_u32 m0, s92, 16384
    s_add_u32 s3, s94, 0
    v_mfma_f32_32x32x16_bf16 v[80:95], v[108:111], a[76:79], v[80:95]
    s_add_u32 s83, s96, 11264
    buffer_load_dwordx4 v[152:155], v22, s[56:59], s83 offen sc1
    s_add_u32 s84, s97, 11264
    buffer_load_dwordx4 v[156:159], v22, s[56:59], s84 offen sc1
    s_add_u32 s83, s96, 12288
    buffer_load_dwordx4 v[160:163], v22, s[56:59], s83 offen sc1
    s_add_u32 s84, s97, 12288
    buffer_load_dwordx4 v[164:167], v22, s[56:59], s84 offen sc1
    s_waitcnt vmcnt(13)
    v_mfma_f32_32x32x16_bf16 v[32:47], v[112:115], a[80:83], v[32:47]
    buffer_load_dwordx4 v234, s[52:55], s3 offen offset:0 lds
    buffer_load_dwordx4 v235, s[52:55], s3 offen offset:1024 lds
    buffer_load_dwordx4 v236, s[52:55], s3 offen offset:2048 lds
    v_mfma_f32_32x32x16_bf16 v[48:63], v[112:115], a[84:87], v[48:63]
    buffer_load_dwordx4 v237, s[52:55], s3 offen offset:3072 lds
    s_add_u32 m0, s92, 20480
    s_add_u32 s3, s90, 0
    s_waitcnt vmcnt(16)
    v_mfma_f32_32x32x16_bf16 v[64:79], v[116:119], a[80:83], v[64:79]
    buffer_load_dwordx4 v234, s[52:55], s3 offen offset:0 lds
    buffer_load_dwordx4 v235, s[52:55], s3 offen offset:1024 lds
    buffer_load_dwordx4 v236, s[52:55], s3 offen offset:2048 lds
    buffer_load_dwordx4 v237, s[52:55], s3 offen offset:3072 lds
    v_mfma_f32_32x32x16_bf16 v[80:95], v[116:119], a[84:87], v[80:95]
    s_add_u32 s83, s96, 13312
    buffer_load_dwordx4 v[168:171], v22, s[56:59], s83 offen sc1
    s_add_u32 s84, s97, 13312
    buffer_load_dwordx4 v[172:175], v22, s[56:59], s84 offen sc1
    s_add_u32 s83, s96, 14336
    buffer_load_dwordx4 v[96:99], v22, s[56:59], s83 offen sc1
    s_add_u32 s84, s97, 14336
    buffer_load_dwordx4 v[100:103], v22, s[56:59], s84 offen sc1
    s_waitcnt vmcnt(23)
    v_mfma_f32_32x32x16_bf16 v[32:47], v[120:123], a[88:91], v[32:47]
    ds_read_b64_tr_b16 a[160:161], v238 offset:24576
    ds_read_b64_tr_b16 a[162:163], v238 offset:25600
    v_mfma_f32_32x32x16_bf16 v[48:63], v[120:123], a[92:95], v[48:63]
    ds_read_b64_tr_b16 a[164:165], v239 offset:24576
    ds_read_b64_tr_b16 a[166:167], v239 offset:25600
    ds_read_b64_tr_b16 a[168:169], v238 offset:26624
    s_waitcnt vmcnt(22)
    v_mfma_f32_32x32x16_bf16 v[64:79], v[124:127], a[88:91], v[64:79]
    ds_read_b64_tr_b16 a[170:171], v238 offset:27648
    ds_read_b64_tr_b16 a[172:173], v239 offset:26624
    ds_read_b64_tr_b16 a[174:175], v239 offset:27648
    ds_read_b64_tr_b16 a[176:177], v238 offset:28672
    v_mfma_f32_32x32x16_bf16 v[80:95], v[124:127], a[92:95], v[80:95]
    s_add_u32 s83, s96, 15360
    buffer_load_dwordx4 v[104:107], v22, s[56:59], s83 offen sc1
    s_add_u32 s84, s97, 15360
    buffer_load_dwordx4 v[108:111], v22, s[56:59], s84 offen sc1
    s_add_u32 s83, s96, 16384
    buffer_load_dwordx4 v[112:115], v22, s[56:59], s83 offen sc1
    s_add_u32 s84, s97, 16384
    buffer_load_dwordx4 v[116:119], v22, s[56:59], s84 offen sc1
    s_waitcnt vmcnt(25)
    v_mfma_f32_32x32x16_bf16 v[32:47], v[128:131], a[96:99], v[32:47]
    ds_read_b64_tr_b16 a[178:179], v238 offset:29696
    ds_read_b64_tr_b16 a[180:181], v239 offset:28672
    ds_read_b64_tr_b16 a[182:183], v239 offset:29696
    v_mfma_f32_32x32x16_bf16 v[48:63], v[128:131], a[100:103], v[48:63]
    ds_read_b64_tr_b16 a[184:185], v238 offset:30720
    ds_read_b64_tr_b16 a[186:187], v238 offset:31744
    ds_read_b64_tr_b16 a[188:189], v239 offset:30720
    s_waitcnt vmcnt(24)
    v_mfma_f32_32x32x16_bf16 v[64:79], v[132:135], a[96:99], v[64:79]
    ds_read_b64_tr_b16 a[190:191], v239 offset:31744
    s_waitcnt lgkmcnt(0)
    s_add_u32 m0, s92, 24576
    s_add_u32 s3, s94, 128
    v_mfma_f32_32x32x16_bf16 v[80:95], v[132:135], a[100:103], v[80:95]
    s_add_u32 s83, s96, 17408
    buffer_load_dwordx4 v[120:123], v22, s[56:59], s83 offen sc1
    s_add_u32 s84, s97, 17408
    buffer_load_dwordx4 v[124:127], v22, s[56:59], s84 offen sc1
    s_add_u32 s83, s96, 22528
    buffer_load_dwordx4 v[128:131], v22, s[56:59], s83 offen sc1
    s_add_u32 s84, s97, 22528
    buffer_load_dwordx4 v[132:135], v22, s[56:59], s84 offen sc1
    s_waitcnt vmcnt(27)
    v_mfma_f32_32x32x16_bf16 v[32:47], v[136:139], a[104:107], v[32:47]
    buffer_load_dwordx4 v234, s[52:55], s3 offen offset:0 lds
    buffer_load_dwordx4 v235, s[52:55], s3 offen offset:1024 lds
    buffer_load_dwordx4 v236, s[52:55], s3 offen offset:2048 lds
    v_mfma_f32_32x32x16_bf16 v[48:63], v[136:139], a[108:111], v[48:63]
    buffer_load_dwordx4 v237, s[52:55], s3 offen offset:3072 lds
    s_add_u32 m0, s92, 28672
    s_add_u32 s3, s90, 128
    s_waitcnt vmcnt(30)
    v_mfma_f32_32x32x16_bf16 v[64:79], v[140:143], a[104:107], v[64:79]
    buffer_load_dwordx4 v234, s[52:55], s3 offen offset:0 lds
    buffer_load_dwordx4 v235, s[52:55], s3 offen offset:1024 lds
    buffer_load_dwordx4 v236, s[52:55], s3 offen offset:2048 lds
    buffer_load_dwordx4 v237, s[52:55], s3 offen offset:3072 lds
    v_mfma_f32_32x32x16_bf16 v[80:95], v[140:143], a[108:111], v[80:95]
    s_add_u32 s83, s96, 23552
    buffer_load_dwordx4 v[136:139], v22, s[56:59], s83 offen sc1
    s_add_u32 s84, s97, 23552
    buffer_load_dwordx4 v[140:143], v22, s[56:59], s84 offen sc1
    s_waitcnt vmcnt(35)
    v_mfma_f32_32x32x16_bf16 v[32:47], v[144:147], a[112:115], v[32:47]
    ds_read_b64_tr_b16 a[192:193], v238 offset:32768
    ds_read_b64_tr_b16 a[194:195], v238 offset:33792
    v_mfma_f32_32x32x16_bf16 v[48:63], v[144:147], a[116:119], v[48:63]
    ds_read_b64_tr_b16 a[196:197], v239 offset:32768
    ds_read_b64_tr_b16 a[198:199], v239 offset:33792
    ds_read_b64_tr_b16 a[200:201], v238 offset:34816
    ds_read_b64_tr_b16 a[202:203], v238 offset:35840
    s_waitcnt vmcnt(34)
    v_mfma_f32_32x32x16_bf16 v[64:79], v[148:151], a[112:115], v[64:79]
    ds_read_b64_tr_b16 a[204:205], v239 offset:34816
    ds_read_b64_tr_b16 a[206:207], v239 offset:35840
    ds_read_b64_tr_b16 a[208:209], v238 offset:36864
    ds_read_b64_tr_b16 a[210:211], v238 offset:37888
    v_mfma_f32_32x32x16_bf16 v[80:95], v[148:151], a[116:119], v[80:95]
    s_add_u32 s83, s96, 24576
    buffer_load_dwordx4 v[144:147], v22, s[56:59], s83 offen sc1
    s_add_u32 s84, s97, 24576
    buffer_load_dwordx4 v[148:151], v22, s[56:59], s84 offen sc1
    s_waitcnt vmcnt(35)
    v_mfma_f32_32x32x16_bf16 v[32:47], v[152:155], a[120:123], v[32:47]
    ds_read_b64_tr_b16 a[212:213], v239 offset:36864
    ds_read_b64_tr_b16 a[214:215], v239 offset:37888
    ds_read_b64_tr_b16 a[216:217], v238 offset:38912
    v_mfma_f32_32x32x16_bf16 v[48:63], v[152:155], a[124:127], v[48:63]
    ds_read_b64_tr_b16 a[218:219], v238 offset:39936
    ds_read_b64_tr_b16 a[220:221], v239 offset:38912
    ds_read_b64_tr_b16 a[222:223], v239 offset:39936
    s_waitcnt lgkmcnt(0)
    s_waitcnt vmcnt(34)
    v_mfma_f32_32x32x16_bf16 v[64:79], v[156:159], a[120:123], v[64:79]
    s_add_u32 m0, s92, 32768
    s_add_u32 s3, s93, 393216
    buffer_load_dwordx4 v232, s[64:67], s3 offen offset:0 lds
    buffer_load_dwordx4 v233, s[64:67], s3 offen offset:1024 lds
    v_mfma_f32_32x32x16_bf16 v[80:95], v[156:159], a[124:127], v[80:95]
    s_add_u32 s83, s96, 25600
    buffer_load_dwordx4 v[152:155], v22, s[56:59], s83 offen sc1
    s_add_u32 s84, s97, 25600
    buffer_load_dwordx4 v[156:159], v22, s[56:59], s84 offen sc1
    s_waitcnt vmcnt(37)
    v_mfma_f32_32x32x16_bf16 v[32:47], v[160:163], a[128:131], v[32:47]
    s_add_u32 m0, s92, 34816
    s_add_u32 s3, s93, 409600
    buffer_load_dwordx4 v232, s[64:67], s3 offen offset:0 lds
    buffer_load_dwordx4 v233, s[64:67], s3 offen offset:1024 lds
    v_mfma_f32_32x32x16_bf16 v[48:63], v[160:163], a[132:135], v[48:63]
    s_add_u32 m0, s92, 36864
    s_add_u32 s3, s93, 425984
    buffer_load_dwordx4 v232, s[64:67], s3 offen offset:0 lds
    buffer_load_dwordx4 v233, s[64:67], s3 offen offset:1024 lds
    s_waitcnt vmcnt(40)
    v_mfma_f32_32x32x16_bf16 v[64:79], v[164:167], a[128:131], v[64:79]
    s_add_u32 m0, s92, 38912
    s_add_u32 s3, s93, 442368
    buffer_load_dwordx4 v232, s[64:67], s3 offen offset:0 lds
    buffer_load_dwordx4 v233, s[64:67], s3 offen offset:1024 lds
    v_mfma_f32_32x32x16_bf16 v[80:95], v[164:167], a[132:135], v[80:95]
    s_add_u32 s83, s96, 26624
    buffer_load_dwordx4 v[160:163], v22, s[56:59], s83 offen sc1
    s_add_u32 s84, s97, 26624
    buffer_load_dwordx4 v[164:167], v22, s[56:59], s84 offen sc1
    s_waitcnt vmcnt(35)
    v_mfma_f32_32x32x16_bf16 v[32:47], v[168:171], a[136:139], v[32:47]
    ds_read_b64_tr_b16 a[224:225], v238 offset:0
    ds_read_b64_tr_b16 a[226:227], v238 offset:1024
    v_mfma_f32_32x32x16_bf16 v[48:63], v[168:171], a[140:143], v[48:63]
    ds_read_b64_tr_b16 a[228:229], v239 offset:0
    ds_read_b64_tr_b16 a[230:231], v239 offset:1024
    ds_read_b64_tr_b16 a[232:233], v238 offset:2048
    s_waitcnt vmcnt(34)
    v_mfma_f32_32x32x16_bf16 v[64:79], v[172:175], a[136:139], v[64:79]
    ds_read_b64_tr_b16 a[234:235], v238 offset:3072
    ds_read_b64_tr_b16 a[236:237], v239 offset:2048
    ds_read_b64_tr_b16 a[238:239], v239 offset:3072
    ds_read_b64_tr_b16 a[240:241], v238 offset:4096
    v_mfma_f32_32x32x16_bf16 v[80:95], v[172:175], a[140:143], v[80:95]
    s_add_u32 s83, s96, 27648
    buffer_load_dwordx4 v[168:171], v22, s[56:59], s83 offen sc1
    s_add_u32 s84, s97, 27648
    buffer_load_dwordx4 v[172:175], v22, s[56:59], s84 offen sc1
    s_waitcnt vmcnt(35)
    v_mfma_f32_32x32x16_bf16 v[32:47], v[96:99], a[144:147], v[32:47]
    ds_read_b64_tr_b16 a[242:243], v238 offset:5120
    ds_read_b64_tr_b16 a[244:245], v239 offset:4096
    ds_read_b64_tr_b16 a[246:247], v239 offset:5120
    v_mfma_f32_32x32x16_bf16 v[48:63], v[96:99], a[148:151], v[48:63]
    ds_read_b64_tr_b16 a[248:249], v238 offset:6144
    ds_read_b64_tr_b16 a[250:251], v238 offset:7168
    ds_read_b64_tr_b16 a[252:253], v239 offset:6144
    s_waitcnt vmcnt(34)
    v_mfma_f32_32x32x16_bf16 v[64:79], v[100:103], a[144:147], v[64:79]
    ds_read_b64_tr_b16 a[254:255], v239 offset:7168
    s_waitcnt lgkmcnt(0)
    s_add_u32 m0, s92, 0
    s_add_u32 s3, s94, 0
    v_mfma_f32_32x32x16_bf16 v[80:95], v[100:103], a[148:151], v[80:95]
    s_add_u32 s83, s96, 28672
    buffer_load_dwordx4 v[96:99], v22, s[56:59], s83 offen sc1
    s_add_u32 s84, s97, 28672
    buffer_load_dwordx4 v[100:103], v22, s[56:59], s84 offen sc1
    s_waitcnt vmcnt(35)
    v_mfma_f32_32x32x16_bf16 v[32:47], v[104:107], a[152:155], v[32:47]
    buffer_load_dwordx4 v234, s[48:51], s3 offen offset:0 lds
    buffer_load_dwordx4 v235, s[48:51], s3 offen offset:1024 lds
    buffer_load_dwordx4 v236, s[48:51], s3 offen offset:2048 lds
    v_mfma_f32_32x32x16_bf16 v[48:63], v[104:107], a[156:159], v[48:63]
    buffer_load_dwordx4 v237, s[48:51], s3 offen offset:3072 lds
    s_add_u32 m0, s92, 4096
    s_add_u32 s3, s90, 0
    s_waitcnt vmcnt(38)
    v_mfma_f32_32x32x16_bf16 v[64:79], v[108:111], a[152:155], v[64:79]
    buffer_load_dwordx4 v234, s[48:51], s3 offen offset:0 lds
    buffer_load_dwordx4 v235, s[48:51], s3 offen offset:1024 lds
    buffer_load_dwordx4 v236, s[48:51], s3 offen offset:2048 lds
    buffer_load_dwordx4 v237, s[48:51], s3 offen offset:3072 lds
    v_mfma_f32_32x32x16_bf16 v[80:95], v[108:111], a[156:159], v[80:95]
    s_add_u32 s83, s96, 33792
    buffer_load_dwordx4 v[104:107], v22, s[56:59], s83 offen sc1
    s_add_u32 s84, s97, 33792
    buffer_load_dwordx4 v[108:111], v22, s[56:59], s84 offen sc1
    s_waitcnt vmcnt(43)
    v_mfma_f32_32x32x16_bf16 v[32:47], v[112:115], a[160:163], v[32:47]
    v_mfma_f32_32x32x16_bf16 v[48:63], v[112:115], a[164:167], v[48:63]
    s_waitcnt vmcnt(42)
    v_mfma_f32_32x32x16_bf16 v[64:79], v[116:119], a[160:163], v[64:79]
    v_mfma_f32_32x32x16_bf16 v[80:95], v[116:119], a[164:167], v[80:95]
    s_add_u32 s83, s96, 34816
    buffer_load_dwordx4 v[112:115], v22, s[56:59], s83 offen sc1
    s_add_u32 s84, s97, 34816
    buffer_load_dwordx4 v[116:119], v22, s[56:59], s84 offen sc1
    s_waitcnt vmcnt(43)
    v_mfma_f32_32x32x16_bf16 v[32:47], v[120:123], a[168:171], v[32:47]
    v_mfma_f32_32x32x16_bf16 v[48:63], v[120:123], a[172:175], v[48:63]
    s_waitcnt vmcnt(42)
    v_mfma_f32_32x32x16_bf16 v[64:79], v[124:127], a[168:171], v[64:79]
    v_mfma_f32_32x32x16_bf16 v[80:95], v[124:127], a[172:175], v[80:95]
    s_add_u32 s83, s96, 35840
    buffer_load_dwordx4 v[120:123], v22, s[56:59], s83 offen sc1
    s_add_u32 s84, s97, 35840
    buffer_load_dwordx4 v[124:127], v22, s[56:59], s84 offen sc1
    s_waitcnt vmcnt(43)
    v_mfma_f32_32x32x16_bf16 v[32:47], v[128:131], a[176:179], v[32:47]
    v_mfma_f32_32x32x16_bf16 v[48:63], v[128:131], a[180:183], v[48:63]
    s_waitcnt vmcnt(42)
    v_mfma_f32_32x32x16_bf16 v[64:79], v[132:135], a[176:179], v[64:79]
    v_mfma_f32_32x32x16_bf16 v[80:95], v[132:135], a[180:183], v[80:95]
    s_add_u32 s83, s96, 29696
    buffer_load_dwordx4 v[128:131], v22, s[56:59], s83 offen sc1
    s_add_u32 s84, s97, 29696
    buffer_load_dwordx4 v[132:135], v22, s[56:59], s84 offen sc1
    s_waitcnt vmcnt(35)
    v_mfma_f32_32x32x16_bf16 v[32:47], v[136:139], a[184:187], v[32:47]
    v_mfma_f32_32x32x16_bf16 v[48:63], v[136:139], a[188:191], v[48:63]
    s_waitcnt vmcnt(34)
    v_mfma_f32_32x32x16_bf16 v[64:79], v[140:143], a[184:187], v[64:79]
    v_mfma_f32_32x32x16_bf16 v[80:95], v[140:143], a[188:191], v[80:95]
    s_add_u32 s83, s96, 30720
    buffer_load_dwordx4 v[136:139], v22, s[56:59], s83 offen sc1
    s_add_u32 s84, s97, 30720
    buffer_load_dwordx4 v[140:143], v22, s[56:59], s84 offen sc1
    s_waitcnt vmcnt(35)
    v_mfma_f32_32x32x16_bf16 v[32:47], v[144:147], a[192:195], v[32:47]
    v_mfma_f32_32x32x16_bf16 v[48:63], v[144:147], a[196:199], v[48:63]
    s_waitcnt vmcnt(34)
    v_mfma_f32_32x32x16_bf16 v[64:79], v[148:151], a[192:195], v[64:79]
    v_mfma_f32_32x32x16_bf16 v[80:95], v[148:151], a[196:199], v[80:95]
    s_add_u32 s83, s96, 40960
    buffer_load_dwordx4 v[144:147], v22, s[56:59], s83 offen sc1
    s_add_u32 s84, s97, 40960
    buffer_load_dwordx4 v[148:151], v22, s[56:59], s84 offen sc1
    s_waitcnt vmcnt(33)
    v_mfma_f32_32x32x16_bf16 v[32:47], v[152:155], a[200:203], v[32:47]
    v_mfma_f32_32x32x16_bf16 v[48:63], v[152:155], a[204:207], v[48:63]
    s_waitcnt vmcnt(32)
    v_mfma_f32_32x32x16_bf16 v[64:79], v[156:159], a[200:203], v[64:79]
    v_mfma_f32_32x32x16_bf16 v[80:95], v[156:159], a[204:207], v[80:95]
    s_add_u32 s83, s96, 41984
    buffer_load_dwordx4 v[152:155], v22, s[56:59], s83 offen sc1
    s_add_u32 s84, s97, 41984
    buffer_load_dwordx4 v[156:159], v22, s[56:59], s84 offen sc1
    s_waitcnt vmcnt(27)
    v_mfma_f32_32x32x16_bf16 v[32:47], v[160:163], a[208:211], v[32:47]
    v_mfma_f32_32x32x16_bf16 v[48:63], v[160:163], a[212:215], v[48:63]
    s_waitcnt vmcnt(26)
    v_mfma_f32_32x32x16_bf16 v[64:79], v[164:167], a[208:211], v[64:79]
    v_mfma_f32_32x32x16_bf16 v[80:95], v[164:167], a[212:215], v[80:95]
    s_add_u32 s83, s96, 9216
    buffer_load_dwordx4 v[160:163], v22, s[56:59], s83 offen sc1
    s_add_u32 s84, s97, 9216
    buffer_load_dwordx4 v[164:167], v22, s[56:59], s84 offen sc1
    s_waitcnt vmcnt(27)
    v_mfma_f32_32x32x16_bf16 v[32:47], v[168:171], a[216:219], v[32:47]
    v_mfma_f32_32x32x16_bf16 v[48:63], v[168:171], a[220:223], v[48:63]
    s_waitcnt vmcnt(26)
    v_mfma_f32_32x32x16_bf16 v[64:79], v[172:175], a[216:219], v[64:79]
    v_mfma_f32_32x32x16_bf16 v[80:95], v[172:175], a[220:223], v[80:95]
    s_add_u32 s83, s96, 10240
    buffer_load_dwordx4 v[168:171], v22, s[56:59], s83 offen sc1
    s_add_u32 s84, s97, 10240
    buffer_load_dwordx4 v[172:175], v22, s[56:59], s84 offen sc1
    s_waitcnt vmcnt(27)
    v_mfma_f32_32x32x16_bf16 v[32:47], v[96:99], a[224:227], v[32:47]
    v_mfma_f32_32x32x16_bf16 v[48:63], v[96:99], a[228:231], v[48:63]
    s_waitcnt vmcnt(26)
    v_mfma_f32_32x32x16_bf16 v[64:79], v[100:103], a[224:227], v[64:79]
    v_mfma_f32_32x32x16_bf16 v[80:95], v[100:103], a[228:231], v[80:95]
    s_add_u32 s83, s96, 20480
    buffer_load_dwordx4 v[96:99], v22, s[56:59], s83 offen sc1
    s_add_u32 s84, s97, 20480
    buffer_load_dwordx4 v[100:103], v22, s[56:59], s84 offen sc1
    s_waitcnt vmcnt(19)
    v_mfma_f32_32x32x16_bf16 v[32:47], v[104:107], a[232:235], v[32:47]
    v_mfma_f32_32x32x16_bf16 v[48:63], v[104:107], a[236:239], v[48:63]
    s_waitcnt vmcnt(18)
    v_mfma_f32_32x32x16_bf16 v[64:79], v[108:111], a[232:235], v[64:79]
    v_mfma_f32_32x32x16_bf16 v[80:95], v[108:111], a[236:239], v[80:95]
    s_add_u32 s83, s96, 21504
    buffer_load_dwordx4 v[104:107], v22, s[56:59], s83 offen sc1
    s_add_u32 s84, s97, 21504
    buffer_load_dwordx4 v[108:111], v22, s[56:59], s84 offen sc1
    s_waitcnt vmcnt(19)
    v_mfma_f32_32x32x16_bf16 v[32:47], v[112:115], a[240:243], v[32:47]
    ds_read_b128 v[176:179], v240 offset:8192
    ds_read_b128 v[180:183], v240 offset:12288
    s_lshl_b32 s98, s41, 7
    v_mfma_f32_32x32x16_bf16 v[48:63], v[112:115], a[244:247], v[48:63]
    s_lshl_b32 s81, s42, 6
    s_add_u32 s98, s98, s81
    s_lshr_b32 s81, s40, 1
    s_lshl_b32 s81, s81, 5
    s_add_u32 s98, s98, s81
    s_waitcnt vmcnt(18)
    v_mfma_f32_32x32x16_bf16 v[64:79], v[116:119], a[240:243], v[64:79]
    s_lshl_b32 s99, s43, 6
    s_and_b32 s81, s40, 1
    s_lshl_b32 s81, s81, 5
    s_add_u32 s99, s99, s81
    v_lshrrev_b32 v25, 5, v1
    v_lshlrev_b32 v26, 6, v25
    v_mfma_f32_32x32x16_bf16 v[80:95], v[116:119], a[244:247], v[80:95]
    s_add_u32 s83, s96, 31744
    buffer_load_dwordx4 v[112:115], v22, s[56:59], s83 offen sc1
    s_add_u32 s84, s97, 31744
    buffer_load_dwordx4 v[116:119], v22, s[56:59], s84 offen sc1
    s_waitcnt vmcnt(19)
    v_mfma_f32_32x32x16_bf16 v[32:47], v[120:123], a[248:251], v[32:47]
    ds_read_b128 v[184:187], v241 offset:8192
    ds_read_b128 v[188:191], v241 offset:12288
    s_lshl_b32 s81, s98, 2
    v_mfma_f32_32x32x16_bf16 v[48:63], v[120:123], a[252:255], v[48:63]
    s_add_u32 s81, s81, 11599872
    buffer_load_dwordx4 v[216:219], v26, s[56:59], s81 offen offset:0 sc1
    buffer_load_dwordx4 v[220:223], v26, s[56:59], s81 offen offset:16 sc1
    buffer_load_dwordx4 v[224:227], v26, s[56:59], s81 offen offset:32 sc1
    buffer_load_dwordx4 v[228:231], v26, s[56:59], s81 offen offset:48 sc1
    s_mov_b32 s68, s20
    s_waitcnt vmcnt(22)
    v_mfma_f32_32x32x16_bf16 v[64:79], v[124:127], a[248:251], v[64:79]
    s_mov_b32 s69, s21
    s_mov_b32 s70, 1024
    s_mov_b32 s71, 0x20000
    v_and_b32 v27, 31, v1
    v_add_u32 v27, s99, v27
    v_lshlrev_b32 v23, 2, v27
    v_mfma_f32_32x32x16_bf16 v[80:95], v[124:127], a[252:255], v[80:95]
    s_add_u32 s83, s96, 32768
    buffer_load_dwordx4 v[120:123], v22, s[56:59], s83 offen sc1
    s_add_u32 s84, s97, 32768
    buffer_load_dwordx4 v[124:127], v22, s[56:59], s84 offen sc1
    s_waitcnt vmcnt(23)
    s_waitcnt lgkmcnt(2)
    v_mfma_f32_32x32x16_bf16 v[32:47], v[128:131], v[176:179], v[32:47]
    ds_read_b128 v[192:195], v242 offset:8192
    ds_read_b128 v[196:199], v242 offset:12288
    v_lshlrev_b32 v27, 1, v27
    v_mfma_f32_32x32x16_bf16 v[48:63], v[128:131], v[180:183], v[48:63]
    buffer_load_ushort v18, v27, s[68:71], 0 offen
    v_lshlrev_b32 v25, 14, v25
    v_add_u32 v27, v27, v25
    s_lshl_b32 s81, s98, 10
    buffer_load_ushort v2, v27, s[44:47], s81 offen offset:0
    s_waitcnt vmcnt(24)
    v_mfma_f32_32x32x16_bf16 v[64:79], v[132:135], v[176:179], v[64:79]
    buffer_load_ushort v4, v27, s[44:47], s81 offen offset:1024
    buffer_load_ushort v6, v27, s[44:47], s81 offen offset:2048
    buffer_load_ushort v8, v27, s[44:47], s81 offen offset:3072
    s_add_u32 s81, s81, 4096
    buffer_load_ushort v10, v27, s[44:47], s81 offen offset:0
    buffer_load_ushort v12, v27, s[44:47], s81 offen offset:1024
    v_mfma_f32_32x32x16_bf16 v[80:95], v[132:135], v[180:183], v[80:95]
    s_add_u32 s83, s96, 43008
    buffer_load_dwordx4 v[128:131], v22, s[56:59], s83 offen sc1
    s_add_u32 s84, s97, 43008
    buffer_load_dwordx4 v[132:135], v22, s[56:59], s84 offen sc1
    s_waitcnt vmcnt(30)
    s_waitcnt lgkmcnt(2)
    v_mfma_f32_32x32x16_bf16 v[32:47], v[136:139], v[184:187], v[32:47]
    ds_read_b128 v[176:179], v243 offset:8192
    ds_read_b128 v[180:183], v243 offset:12288
    buffer_load_ushort v14, v27, s[44:47], s81 offen offset:2048
    v_mfma_f32_32x32x16_bf16 v[48:63], v[136:139], v[188:191], v[48:63]
    buffer_load_ushort v16, v27, s[44:47], s81 offen offset:3072
    s_add_u32 s81, s81, 4096
    buffer_load_ushort v3, v27, s[44:47], s81 offen offset:0
    buffer_load_ushort v5, v27, s[44:47], s81 offen offset:1024
    buffer_load_ushort v7, v27, s[44:47], s81 offen offset:2048
    buffer_load_ushort v9, v27, s[44:47], s81 offen offset:3072
    s_waitcnt vmcnt(35)
    v_mfma_f32_32x32x16_bf16 v[64:79], v[140:143], v[184:187], v[64:79]
    s_add_u32 s81, s81, 4096
    buffer_load_ushort v11, v27, s[44:47], s81 offen offset:0
    buffer_load_ushort v13, v27, s[44:47], s81 offen offset:1024
    buffer_load_ushort v15, v27, s[44:47], s81 offen offset:2048
    buffer_load_ushort v17, v27, s[44:47], s81 offen offset:3072
    v_lshl_add_u32 v23, v25, 1, v23
    v_mfma_f32_32x32x16_bf16 v[80:95], v[140:143], v[188:191], v[80:95]
    s_add_u32 s83, s96, 44032
    buffer_load_dwordx4 v[136:139], v22, s[56:59], s83 offen sc1
    s_add_u32 s84, s97, 44032
    buffer_load_dwordx4 v[140:143], v22, s[56:59], s84 offen sc1
    s_waitcnt vmcnt(40)
    s_waitcnt lgkmcnt(2)
    v_mfma_f32_32x32x16_bf16 v[32:47], v[144:147], v[192:195], v[32:47]
    v_mfma_f32_32x32x16_bf16 v[48:63], v[144:147], v[196:199], v[48:63]
    s_waitcnt vmcnt(39)
    v_mfma_f32_32x32x16_bf16 v[64:79], v[148:151], v[192:195], v[64:79]
    ds_read_b128 v[184:187], v240 offset:16384
    ds_read_b128 v[188:191], v240 offset:20480
    v_mfma_f32_32x32x16_bf16 v[80:95], v[148:151], v[196:199], v[80:95]
    s_add_u32 s83, s96, 36864
    buffer_load_dwordx4 v[144:147], v22, s[56:59], s83 offen sc1
    s_add_u32 s84, s97, 36864
    buffer_load_dwordx4 v[148:151], v22, s[56:59], s84 offen sc1
    s_waitcnt vmcnt(40)
    s_waitcnt lgkmcnt(2)
    v_mfma_f32_32x32x16_bf16 v[32:47], v[152:155], v[176:179], v[32:47]
    v_mfma_f32_32x32x16_bf16 v[48:63], v[152:155], v[180:183], v[48:63]
    s_waitcnt vmcnt(39)
    v_mfma_f32_32x32x16_bf16 v[64:79], v[156:159], v[176:179], v[64:79]
    ds_read_b128 v[192:195], v241 offset:16384
    ds_read_b128 v[196:199], v241 offset:20480
    v_mfma_f32_32x32x16_bf16 v[80:95], v[156:159], v[180:183], v[80:95]
    s_add_u32 s83, s96, 37888
    buffer_load_dwordx4 v[152:155], v22, s[56:59], s83 offen sc1
    s_add_u32 s84, s97, 37888
    buffer_load_dwordx4 v[156:159], v22, s[56:59], s84 offen sc1
    s_waitcnt vmcnt(40)
    s_waitcnt lgkmcnt(2)
    v_mfma_f32_32x32x16_bf16 v[32:47], v[160:163], v[184:187], v[32:47]
    v_mfma_f32_32x32x16_bf16 v[48:63], v[160:163], v[188:191], v[48:63]
    s_waitcnt vmcnt(39)
    v_mfma_f32_32x32x16_bf16 v[64:79], v[164:167], v[184:187], v[64:79]
    ds_read_b128 v[176:179], v242 offset:16384
    ds_read_b128 v[180:183], v242 offset:20480
    v_mfma_f32_32x32x16_bf16 v[80:95], v[164:167], v[188:191], v[80:95]
    s_add_u32 s83, s96, 38912
    buffer_load_dwordx4 v[160:163], v22, s[56:59], s83 offen sc1
    s_add_u32 s84, s97, 38912
    buffer_load_dwordx4 v[164:167], v22, s[56:59], s84 offen sc1
    s_waitcnt vmcnt(40)
    s_waitcnt lgkmcnt(2)
    v_mfma_f32_32x32x16_bf16 v[32:47], v[168:171], v[192:195], v[32:47]
    v_mfma_f32_32x32x16_bf16 v[48:63], v[168:171], v[196:199], v[48:63]
    s_waitcnt vmcnt(39)
    v_mfma_f32_32x32x16_bf16 v[64:79], v[172:175], v[192:195], v[64:79]
    ds_read_b128 v[184:187], v243 offset:16384
    ds_read_b128 v[188:191], v243 offset:20480
    v_mfma_f32_32x32x16_bf16 v[80:95], v[172:175], v[196:199], v[80:95]
    s_add_u32 s83, s96, 39936
    buffer_load_dwordx4 v[168:171], v22, s[56:59], s83 offen sc1
    s_add_u32 s84, s97, 39936
    buffer_load_dwordx4 v[172:175], v22, s[56:59], s84 offen sc1
    s_waitcnt vmcnt(40)
    s_waitcnt lgkmcnt(2)
    v_mfma_f32_32x32x16_bf16 v[32:47], v[96:99], v[176:179], v[32:47]
    v_mfma_f32_32x32x16_bf16 v[48:63], v[96:99], v[180:183], v[48:63]
    s_waitcnt vmcnt(39)
    v_mfma_f32_32x32x16_bf16 v[64:79], v[100:103], v[176:179], v[64:79]
    ds_read_b128 v[192:195], v240 offset:24576
    ds_read_b128 v[196:199], v240 offset:28672
    v_mfma_f32_32x32x16_bf16 v[80:95], v[100:103], v[180:183], v[80:95]
    s_add_u32 s83, s96, 7168
    buffer_load_dwordx4 v[96:99], v22, s[56:59], s83 offen sc1
    s_add_u32 s84, s97, 7168
    buffer_load_dwordx4 v[100:103], v22, s[56:59], s84 offen sc1
    s_waitcnt vmcnt(40)
    s_waitcnt lgkmcnt(2)
    v_mfma_f32_32x32x16_bf16 v[32:47], v[104:107], v[184:187], v[32:47]
    v_mfma_f32_32x32x16_bf16 v[48:63], v[104:107], v[188:191], v[48:63]
    s_waitcnt vmcnt(39)
    v_mfma_f32_32x32x16_bf16 v[64:79], v[108:111], v[184:187], v[64:79]
    ds_read_b128 v[176:179], v241 offset:24576
    ds_read_b128 v[180:183], v241 offset:28672
    v_mfma_f32_32x32x16_bf16 v[80:95], v[108:111], v[188:191], v[80:95]
    s_add_u32 s83, s96, 8192
    buffer_load_dwordx4 v[104:107], v22, s[56:59], s83 offen sc1
    s_add_u32 s84, s97, 8192
    buffer_load_dwordx4 v[108:111], v22, s[56:59], s84 offen sc1
    s_waitcnt vmcnt(40)
    s_waitcnt lgkmcnt(2)
    v_mfma_f32_32x32x16_bf16 v[32:47], v[112:115], v[192:195], v[32:47]
    ds_read_b128 v[184:187], v242 offset:24576
    ds_read_b128 v[188:191], v242 offset:28672
    s_waitcnt vmcnt(14)
    v_mfma_f32_32x32x16_bf16 v[48:63], v[112:115], v[196:199], v[48:63]
    v_lshlrev_b32 v18, 16, v18
    v_lshlrev_b32 v2, 16, v2
    v_lshlrev_b32 v3, 16, v3
    v_lshlrev_b32 v4, 16, v4
    v_lshlrev_b32 v5, 16, v5
    v_mfma_f32_32x32x16_bf16 v[64:79], v[116:119], v[192:195], v[64:79]
    v_lshlrev_b32 v6, 16, v6
    v_lshlrev_b32 v7, 16, v7
    v_lshlrev_b32 v8, 16, v8
    v_lshlrev_b32 v9, 16, v9
    v_lshlrev_b32 v10, 16, v10
    v_mfma_f32_32x32x16_bf16 v[80:95], v[116:119], v[196:199], v[80:95]
    s_add_u32 s83, s96, 18432
    buffer_load_dwordx4 v[112:115], v22, s[56:59], s83 offen sc1
    s_add_u32 s84, s97, 18432
    buffer_load_dwordx4 v[116:119], v22, s[56:59], s84 offen sc1
    s_waitcnt lgkmcnt(2)
    v_mfma_f32_32x32x16_bf16 v[32:47], v[120:123], v[176:179], v[32:47]
    ds_read_b128 v[192:195], v243 offset:24576
    ds_read_b128 v[196:199], v243 offset:28672
    v_lshlrev_b32 v11, 16, v11
    v_mfma_f32_32x32x16_bf16 v[48:63], v[120:123], v[180:183], v[48:63]
    v_lshlrev_b32 v12, 16, v12
    v_lshlrev_b32 v13, 16, v13
    v_lshlrev_b32 v14, 16, v14
    v_lshlrev_b32 v15, 16, v15
    v_lshlrev_b32 v16, 16, v16
    v_mfma_f32_32x32x16_bf16 v[64:79], v[124:127], v[176:179], v[64:79]
    v_lshlrev_b32 v17, 16, v17
    v_mul_f32 v2, v2, v18
    v_mul_f32 v3, v3, v18
    v_mul_f32 v4, v4, v18
    v_mul_f32 v5, v5, v18
    v_mfma_f32_32x32x16_bf16 v[80:95], v[124:127], v[180:183], v[80:95]
    s_add_u32 s83, s96, 19456
    buffer_load_dwordx4 v[120:123], v22, s[56:59], s83 offen sc1
    s_add_u32 s84, s97, 19456
    buffer_load_dwordx4 v[124:127], v22, s[56:59], s84 offen sc1
    s_waitcnt lgkmcnt(2)
    v_mfma_f32_32x32x16_bf16 v[32:47], v[128:131], v[184:187], v[32:47]
    ds_read_b64_tr_b16 v[176:177], v238 offset:32768
    ds_read_b64_tr_b16 v[178:179], v238 offset:33792
    ds_read_b64_tr_b16 v[180:181], v239 offset:32768
    ds_read_b64_tr_b16 v[182:183], v239 offset:33792
    v_mfma_f32_32x32x16_bf16 v[48:63], v[128:131], v[188:191], v[48:63]
    v_mul_f32 v6, v6, v18
    v_mul_f32 v7, v7, v18
    v_mul_f32 v8, v8, v18
    v_mul_f32 v9, v9, v18
    v_mul_f32 v10, v10, v18
    v_mfma_f32_32x32x16_bf16 v[64:79], v[132:135], v[184:187], v[64:79]
    v_mul_f32 v11, v11, v18
    v_mul_f32 v12, v12, v18
    v_mul_f32 v13, v13, v18
    v_mul_f32 v14, v14, v18
    v_mul_f32 v15, v15, v18
    v_mul_f32 v16, v16, v18
    v_mfma_f32_32x32x16_bf16 v[80:95], v[132:135], v[188:191], v[80:95]
    s_waitcnt vmcnt(17)
    s_waitcnt lgkmcnt(4)
    v_mfma_f32_32x32x16_bf16 v[32:47], v[136:139], v[192:195], v[32:47]
    ds_read_b64_tr_b16 v[184:185], v238 offset:34816
    ds_read_b64_tr_b16 v[186:187], v238 offset:35840
    ds_read_b64_tr_b16 v[188:189], v239 offset:34816
    ds_read_b64_tr_b16 v[190:191], v239 offset:35840
    v_mfma_f32_32x32x16_bf16 v[48:63], v[136:139], v[196:199], v[48:63]
    v_mul_f32 v17, v17, v18
    v_cvt_pk_bf16_f32 v2, v2, v3
    v_cvt_pk_bf16_f32 v4, v4, v5
    v_cvt_pk_bf16_f32 v6, v6, v7
    v_cvt_pk_bf16_f32 v8, v8, v9
    v_cvt_pk_bf16_f32 v10, v10, v11
    s_waitcnt vmcnt(16)
    v_mfma_f32_32x32x16_bf16 v[64:79], v[140:143], v[192:195], v[64:79]
    v_cvt_pk_bf16_f32 v12, v12, v13
    v_cvt_pk_bf16_f32 v14, v14, v15
    v_cvt_pk_bf16_f32 v16, v16, v17
    v_and_b32 v3, 0xffff0000, v2
    v_lshlrev_b32 v2, 16, v2
    v_and_b32 v5, 0xffff0000, v4
    v_mfma_f32_32x32x16_bf16 v[80:95], v[140:143], v[196:199], v[80:95]
    s_waitcnt vmcnt(15)
    s_waitcnt lgkmcnt(4)
    v_mfma_f32_32x32x16_bf16 v[32:47], v[144:147], v[176:179], v[32:47]
    ds_read_b64_tr_b16 v[192:193], v238 offset:36864
    ds_read_b64_tr_b16 v[194:195], v238 offset:37888
    ds_read_b64_tr_b16 v[196:197], v239 offset:36864
    ds_read_b64_tr_b16 v[198:199], v239 offset:37888
    v_mfma_f32_32x32x16_bf16 v[48:63], v[144:147], v[180:183], v[48:63]
    v_lshlrev_b32 v4, 16, v4
    v_and_b32 v7, 0xffff0000, v6
    v_lshlrev_b32 v6, 16, v6
    v_and_b32 v9, 0xffff0000, v8
    v_lshlrev_b32 v8, 16, v8
    s_waitcnt vmcnt(14)
    v_mfma_f32_32x32x16_bf16 v[64:79], v[148:151], v[176:179], v[64:79]
    v_and_b32 v11, 0xffff0000, v10
    v_lshlrev_b32 v10, 16, v10
    v_and_b32 v13, 0xffff0000, v12
    v_lshlrev_b32 v12, 16, v12
    v_and_b32 v15, 0xffff0000, v14
    v_lshlrev_b32 v14, 16, v14
    v_mfma_f32_32x32x16_bf16 v[80:95], v[148:151], v[180:183], v[80:95]
    s_waitcnt vmcnt(13)
    s_waitcnt lgkmcnt(4)
    v_mfma_f32_32x32x16_bf16 v[32:47], v[152:155], v[184:187], v[32:47]
    ds_read_b64_tr_b16 v[176:177], v238 offset:38912
    ds_read_b64_tr_b16 v[178:179], v238 offset:39936
    ds_read_b64_tr_b16 v[180:181], v239 offset:38912
    ds_read_b64_tr_b16 v[182:183], v239 offset:39936
    v_mfma_f32_32x32x16_bf16 v[48:63], v[152:155], v[188:191], v[48:63]
    v_and_b32 v17, 0xffff0000, v16
    v_lshlrev_b32 v16, 16, v16
    v_mul_f32 v2, v2, v216
    v_mul_f32 v3, v3, v217
    v_mul_f32 v4, v4, v218
    s_waitcnt vmcnt(12)
    v_mfma_f32_32x32x16_bf16 v[64:79], v[156:159], v[184:187], v[64:79]
    v_mul_f32 v5, v5, v219
    v_mul_f32 v6, v6, v220
    v_mul_f32 v7, v7, v221
    v_mul_f32 v8, v8, v222
    v_mul_f32 v9, v9, v223
    v_mul_f32 v10, v10, v224
    v_mfma_f32_32x32x16_bf16 v[80:95], v[156:159], v[188:191], v[80:95]
    s_waitcnt vmcnt(11)
    s_waitcnt lgkmcnt(4)
    v_mfma_f32_32x32x16_bf16 v[32:47], v[160:163], v[192:195], v[32:47]
    ds_read_b128 v[184:187], v240 offset:0
    ds_read_b128 v[188:191], v240 offset:4096
    v_mul_f32 v11, v11, v225
    v_mfma_f32_32x32x16_bf16 v[48:63], v[160:163], v[196:199], v[48:63]
    v_mul_f32 v12, v12, v226
    v_mul_f32 v13, v13, v227
    v_mul_f32 v14, v14, v228
    v_mul_f32 v15, v15, v229
    v_mul_f32 v16, v16, v230
    s_waitcnt vmcnt(10)
    v_mfma_f32_32x32x16_bf16 v[64:79], v[164:167], v[192:195], v[64:79]
    v_mul_f32 v17, v17, v231
    v_lshlrev_b32 v25, 4, v1
    s_xor_b32 s81, s40, 1
    s_mul_i32 s81, s81, 40960
    v_add_u32 v26, s81, v25
    v_mfma_f32_32x32x16_bf16 v[80:95], v[164:167], v[196:199], v[80:95]
    s_waitcnt vmcnt(9)
    s_waitcnt lgkmcnt(2)
    v_mfma_f32_32x32x16_bf16 v[32:47], v[168:171], v[176:179], v[32:47]
    ds_read_b128 v[192:195], v241 offset:0
    ds_read_b128 v[196:199], v241 offset:4096
    s_xor_b32 s81, s40, 2
    v_mfma_f32_32x32x16_bf16 v[48:63], v[168:171], v[180:183], v[48:63]
    s_mul_i32 s81, s81, 40960
    v_add_u32 v27, s81, v25
    s_xor_b32 s81, s40, 3
    s_mul_i32 s81, s81, 40960
    v_add_u32 v28, s81, v25
    s_waitcnt vmcnt(8)
    v_mfma_f32_32x32x16_bf16 v[64:79], v[172:175], v[176:179], v[64:79]
    v_add_u32 v25, s92, v25
    s_mov_b32 s68, s32
    s_mov_b32 s69, s33
    s_mov_b32 s70, 4194304
    s_mov_b32 s71, 0x20000
    s_lshl_b32 s98, s98, 11
    v_mfma_f32_32x32x16_bf16 v[80:95], v[172:175], v[180:183], v[80:95]
    s_waitcnt vmcnt(7)
    s_waitcnt lgkmcnt(2)
    v_mfma_f32_32x32x16_bf16 v[32:47], v[96:99], v[184:187], v[32:47]
    v_mfma_f32_32x32x16_bf16 v[48:63], v[96:99], v[188:191], v[48:63]
    s_waitcnt vmcnt(6)
    v_mfma_f32_32x32x16_bf16 v[64:79], v[100:103], v[184:187], v[64:79]
    ds_read_b128 v[176:179], v242 offset:0
    ds_read_b128 v[180:183], v242 offset:4096
    v_mfma_f32_32x32x16_bf16 v[80:95], v[100:103], v[188:191], v[80:95]
    s_waitcnt vmcnt(5)
    s_waitcnt lgkmcnt(2)
    v_mfma_f32_32x32x16_bf16 v[32:47], v[104:107], v[192:195], v[32:47]
    v_mfma_f32_32x32x16_bf16 v[48:63], v[104:107], v[196:199], v[48:63]
    s_waitcnt vmcnt(4)
    v_mfma_f32_32x32x16_bf16 v[64:79], v[108:111], v[192:195], v[64:79]
    ds_read_b128 v[184:187], v243 offset:0
    ds_read_b128 v[188:191], v243 offset:4096
    v_mfma_f32_32x32x16_bf16 v[80:95], v[108:111], v[196:199], v[80:95]
    s_waitcnt vmcnt(3)
    s_waitcnt lgkmcnt(2)
    v_mfma_f32_32x32x16_bf16 v[32:47], v[112:115], v[176:179], v[32:47]
    v_mfma_f32_32x32x16_bf16 v[48:63], v[112:115], v[180:183], v[48:63]
    s_waitcnt vmcnt(2)
    v_mfma_f32_32x32x16_bf16 v[64:79], v[116:119], v[176:179], v[64:79]
    v_mfma_f32_32x32x16_bf16 v[80:95], v[116:119], v[180:183], v[80:95]
    s_waitcnt vmcnt(1)
    s_waitcnt lgkmcnt(0)
    v_mfma_f32_32x32x16_bf16 v[32:47], v[120:123], v[184:187], v[32:47]
    v_mfma_f32_32x32x16_bf16 v[48:63], v[120:123], v[188:191], v[48:63]
    s_waitcnt vmcnt(0)
    v_mfma_f32_32x32x16_bf16 v[64:79], v[124:127], v[184:187], v[64:79]
    v_mfma_f32_32x32x16_bf16 v[80:95], v[124:127], v[188:191], v[80:95]
    s_nop 8
    ds_write_b128 v25, v[48:51] offset:0
    ds_write_b128 v25, v[52:55] offset:1024
    ds_write_b128 v25, v[56:59] offset:2048
    ds_write_b128 v25, v[60:63] offset:3072
    ds_write_b128 v25, v[64:67] offset:4096
    ds_write_b128 v25, v[68:71] offset:5120
    ds_write_b128 v25, v[72:75] offset:6144
    ds_write_b128 v25, v[76:79] offset:7168
    ds_write_b128 v25, v[80:83] offset:8192
    ds_write_b128 v25, v[84:87] offset:9216
    ds_write_b128 v25, v[88:91] offset:10240
    ds_write_b128 v25, v[92:95] offset:11264
    v_pk_add_f32 v[32:33], v[32:33], v[2:3]
    v_pk_add_f32 v[34:35], v[34:35], v[4:5]
    v_pk_add_f32 v[36:37], v[36:37], v[6:7]
    v_pk_add_f32 v[38:39], v[38:39], v[8:9]
    v_pk_add_f32 v[40:41], v[40:41], v[10:11]
    v_pk_add_f32 v[42:43], v[42:43], v[12:13]
    v_pk_add_f32 v[44:45], v[44:45], v[14:15]
    v_pk_add_f32 v[46:47], v[46:47], v[16:17]
    s_waitcnt lgkmcnt(0)
    s_barrier
    ds_read_b128 v[96:99], v26 offset:0
    ds_read_b128 v[100:103], v26 offset:1024
    ds_read_b128 v[104:107], v26 offset:2048
    ds_read_b128 v[108:111], v26 offset:3072
    ds_read_b128 v[112:115], v27 offset:4096
    ds_read_b128 v[116:119], v27 offset:5120
    ds_read_b128 v[120:123], v27 offset:6144
    ds_read_b128 v[124:127], v27 offset:7168
    ds_read_b128 v[128:131], v28 offset:8192
    ds_read_b128 v[132:135], v28 offset:9216
    ds_read_b128 v[136:139], v28 offset:10240
    ds_read_b128 v[140:143], v28 offset:11264
    s_waitcnt lgkmcnt(11)
    v_pk_add_f32 v[32:33], v[32:33], v[96:97]
    v_pk_add_f32 v[34:35], v[34:35], v[98:99]
    s_waitcnt lgkmcnt(10)
    v_pk_add_f32 v[36:37], v[36:37], v[100:101]
    v_pk_add_f32 v[38:39], v[38:39], v[102:103]
    s_waitcnt lgkmcnt(9)
    v_pk_add_f32 v[40:41], v[40:41], v[104:105]
    v_pk_add_f32 v[42:43], v[42:43], v[106:107]
    s_waitcnt lgkmcnt(8)
    v_pk_add_f32 v[44:45], v[44:45], v[108:109]
    v_pk_add_f32 v[46:47], v[46:47], v[110:111]
    s_waitcnt lgkmcnt(7)
    v_pk_add_f32 v[32:33], v[32:33], v[112:113]
    v_pk_add_f32 v[34:35], v[34:35], v[114:115]
    s_waitcnt lgkmcnt(6)
    v_pk_add_f32 v[36:37], v[36:37], v[116:117]
    v_pk_add_f32 v[38:39], v[38:39], v[118:119]
    s_waitcnt lgkmcnt(5)
    v_pk_add_f32 v[40:41], v[40:41], v[120:121]
    v_pk_add_f32 v[42:43], v[42:43], v[122:123]
    s_waitcnt lgkmcnt(4)
    v_pk_add_f32 v[44:45], v[44:45], v[124:125]
    v_pk_add_f32 v[46:47], v[46:47], v[126:127]
    s_waitcnt lgkmcnt(3)
    v_pk_add_f32 v[32:33], v[32:33], v[128:129]
    v_pk_add_f32 v[34:35], v[34:35], v[130:131]
    s_waitcnt lgkmcnt(2)
    v_pk_add_f32 v[36:37], v[36:37], v[132:133]
    v_pk_add_f32 v[38:39], v[38:39], v[134:135]
    s_waitcnt lgkmcnt(1)
    v_pk_add_f32 v[40:41], v[40:41], v[136:137]
    v_pk_add_f32 v[42:43], v[42:43], v[138:139]
    s_waitcnt lgkmcnt(0)
    v_pk_add_f32 v[44:45], v[44:45], v[140:141]
    v_pk_add_f32 v[46:47], v[46:47], v[142:143]
    buffer_store_dword v32, v23, s[68:71], s98 offen offset:0 sc1
    buffer_store_dword v34, v23, s[68:71], s98 offen offset:2048 sc1
    s_add_u32 s98, s98, 4096
    buffer_store_dword v36, v23, s[68:71], s98 offen offset:0 sc1
    buffer_store_dword v38, v23, s[68:71], s98 offen offset:2048 sc1
    s_add_u32 s98, s98, 4096
    buffer_store_dword v40, v23, s[68:71], s98 offen offset:0 sc1
    buffer_store_dword v42, v23, s[68:71], s98 offen offset:2048 sc1
    s_add_u32 s98, s98, 4096
    buffer_store_dword v44, v23, s[68:71], s98 offen offset:0 sc1
    buffer_store_dword v46, v23, s[68:71], s98 offen offset:2048 sc1
    s_add_u32 s98, s98, 4096
    buffer_store_dword v33, v23, s[68:71], s98 offen offset:0 sc1
    buffer_store_dword v35, v23, s[68:71], s98 offen offset:2048 sc1
    s_add_u32 s98, s98, 4096
    buffer_store_dword v37, v23, s[68:71], s98 offen offset:0 sc1
    buffer_store_dword v39, v23, s[68:71], s98 offen offset:2048 sc1
    s_add_u32 s98, s98, 4096
    buffer_store_dword v41, v23, s[68:71], s98 offen offset:0 sc1
    buffer_store_dword v43, v23, s[68:71], s98 offen offset:2048 sc1
    s_add_u32 s98, s98, 4096
    buffer_store_dword v45, v23, s[68:71], s98 offen offset:0 sc1
    buffer_store_dword v47, v23, s[68:71], s98 offen offset:2048 sc1
    s_endpgm
L_slow_g:
    s_mov_b32 s88, 0
L_loop_g:
    buffer_load_dword v23, v24, s[60:63], 0 offen sc1
    s_waitcnt vmcnt(0)
    s_add_u32 s88, s88, 1
    s_cmp_gt_u32 s88, 100000
    s_cbranch_scc1 L_back_g
    v_cmp_eq_u32 vcc, 16, v23
    s_nop 4
    s_lshl_b32 s81, 2, s38
    s_sub_u32 s81, s81, 1
    s_lshl_b32 s82, 1, s41
    s_or_b32 s81, s81, s82
    s_and_b32 s82, vcc_lo, s81
    s_cmp_eq_u32 s82, s81
    s_cbranch_scc1 L_back_g
    s_branch L_loop_g
L_slow_e:
    s_mov_b32 s88, 0
L_loop_e:
    s_add_u32 s68, s36, 11534336
    s_addc_u32 s69, s37, 0
    s_mov_b32 s70, 65536
    s_mov_b32 s71, 0x20000
    v_and_b32 v27, 31, v1
    v_lshlrev_b32 v27, 3, v27
    s_lshl_b32 s82, s39, 8
    s_lshl_b32 s81, s38, 12
    s_add_u32 s81, s81, s82
    s_sub_u32 s81, s81, 4096
    v_add_u32 v27, s81, v27
    buffer_load_dwordx2 a[0:1], v27, s[68:71], 0 offen sc1
    v_subrev_u32 v28, 4096, v27
    buffer_load_dwordx2 a[2:3], v28, s[68:71], 0 offen sc1
    v_subrev_u32 v27, 4096, v28
    buffer_load_dwordx2 a[4:5], v27, s[68:71], 0 offen sc1
    v_subrev_u32 v28, 4096, v27
    buffer_load_dwordx2 a[6:7], v28, s[68:71], 0 offen sc1
    v_subrev_u32 v27, 4096, v28
    buffer_load_dwordx2 a[8:9], v27, s[68:71], 0 offen sc1
    v_subrev_u32 v28, 4096, v27
    buffer_load_dwordx2 a[10:11], v28, s[68:71], 0 offen sc1
    v_subrev_u32 v27, 4096, v28
    buffer_load_dwordx2 a[12:13], v27, s[68:71], 0 offen sc1
    v_subrev_u32 v28, 4096, v27
    buffer_load_dwordx2 a[14:15], v28, s[68:71], 0 offen sc1
    v_subrev_u32 v27, 4096, v28
    buffer_load_dwordx2 a[16:17], v27, s[68:71], 0 offen sc1
    v_subrev_u32 v28, 4096, v27
    buffer_load_dwordx2 a[18:19], v28, s[68:71], 0 offen sc1
    v_subrev_u32 v27, 4096, v28
    buffer_load_dwordx2 a[20:21], v27, s[68:71], 0 offen sc1
    v_subrev_u32 v28, 4096, v27
    buffer_load_dwordx2 a[22:23], v28, s[68:71], 0 offen sc1
    v_subrev_u32 v27, 4096, v28
    buffer_load_dwordx2 a[24:25], v27, s[68:71], 0 offen sc1
    v_subrev_u32 v28, 4096, v27
    buffer_load_dwordx2 a[26:27], v28, s[68:71], 0 offen sc1
    v_subrev_u32 v27, 4096, v28
    buffer_load_dwordx2 a[28:29], v27, s[68:71], 0 offen sc1
    s_waitcnt vmcnt(0)
    v_accvgpr_read_b32 v182, a28
    v_accvgpr_read_b32 v183, a29
    v_accvgpr_read_b32 v206, a26
    v_accvgpr_read_b32 v207, a27
    s_nop 0
    v_pk_fma_f32 v[184:185], v[178:179], v[182:183], v[206:207] op_sel:[0,0,0] op_sel_hi:[0,1,1]
    v_pk_fma_f32 v[184:185], v[178:179], v[182:183], v[184:185] op_sel:[1,1,0] op_sel_hi:[1,0,1] neg_lo:[1,0,0]
    v_accvgpr_read_b32 v204, a24
    v_accvgpr_read_b32 v205, a25
    s_nop 0
    v_pk_fma_f32 v[182:183], v[178:179], v[184:185], v[204:205] op_sel:[0,0,0] op_sel_hi:[0,1,1]
    v_pk_fma_f32 v[182:183], v[178:179], v[184:185], v[182:183] op_sel:[1,1,0] op_sel_hi:[1,0,1] neg_lo:[1,0,0]
    v_accvgpr_read_b32 v206, a22
    v_accvgpr_read_b32 v207, a23
    s_nop 0
    v_pk_fma_f32 v[184:185], v[178:179], v[182:183], v[206:207] op_sel:[0,0,0] op_sel_hi:[0,1,1]
    v_pk_fma_f32 v[184:185], v[178:179], v[182:183], v[184:185] op_sel:[1,1,0] op_sel_hi:[1,0,1] neg_lo:[1,0,0]
    v_accvgpr_read_b32 v204, a20
    v_accvgpr_read_b32 v205, a21
    s_nop 0
    v_pk_fma_f32 v[182:183], v[178:179], v[184:185], v[204:205] op_sel:[0,0,0] op_sel_hi:[0,1,1]
    v_pk_fma_f32 v[182:183], v[178:179], v[184:185], v[182:183] op_sel:[1,1,0] op_sel_hi:[1,0,1] neg_lo:[1,0,0]
    v_accvgpr_read_b32 v206, a18
    v_accvgpr_read_b32 v207, a19
    s_nop 0
    v_pk_fma_f32 v[184:185], v[178:179], v[182:183], v[206:207] op_sel:[0,0,0] op_sel_hi:[0,1,1]
    v_pk_fma_f32 v[184:185], v[178:179], v[182:183], v[184:185] op_sel:[1,1,0] op_sel_hi:[1,0,1] neg_lo:[1,0,0]
    v_accvgpr_read_b32 v204, a16
    v_accvgpr_read_b32 v205, a17
    s_nop 0
    v_pk_fma_f32 v[182:183], v[178:179], v[184:185], v[204:205] op_sel:[0,0,0] op_sel_hi:[0,1,1]
    v_pk_fma_f32 v[182:183], v[178:179], v[184:185], v[182:183] op_sel:[1,1,0] op_sel_hi:[1,0,1] neg_lo:[1,0,0]
    v_accvgpr_read_b32 v206, a14
    v_accvgpr_read_b32 v207, a15
    s_nop 0
    v_pk_fma_f32 v[184:185], v[178:179], v[182:183], v[206:207] op_sel:[0,0,0] op_sel_hi:[0,1,1]
    v_pk_fma_f32 v[184:185], v[178:179], v[182:183], v[184:185] op_sel:[1,1,0] op_sel_hi:[1,0,1] neg_lo:[1,0,0]
    v_accvgpr_read_b32 v204, a12
    v_accvgpr_read_b32 v205, a13
    s_nop 0
    v_pk_fma_f32 v[182:183], v[178:179], v[184:185], v[204:205] op_sel:[0,0,0] op_sel_hi:[0,1,1]
    v_pk_fma_f32 v[182:183], v[178:179], v[184:185], v[182:183] op_sel:[1,1,0] op_sel_hi:[1,0,1] neg_lo:[1,0,0]
    v_accvgpr_read_b32 v206, a10
    v_accvgpr_read_b32 v207, a11
    s_nop 0
    v_pk_fma_f32 v[184:185], v[178:179], v[182:183], v[206:207] op_sel:[0,0,0] op_sel_hi:[0,1,1]
    v_pk_fma_f32 v[184:185], v[178:179], v[182:183], v[184:185] op_sel:[1,1,0] op_sel_hi:[1,0,1] neg_lo:[1,0,0]
    v_accvgpr_read_b32 v204, a8
    v_accvgpr_read_b32 v205, a9
    s_nop 0
    v_pk_fma_f32 v[182:183], v[178:179], v[184:185], v[204:205] op_sel:[0,0,0] op_sel_hi:[0,1,1]
    v_pk_fma_f32 v[182:183], v[178:179], v[184:185], v[182:183] op_sel:[1,1,0] op_sel_hi:[1,0,1] neg_lo:[1,0,0]
    v_accvgpr_read_b32 v206, a6
    v_accvgpr_read_b32 v207, a7
    s_nop 0
    v_pk_fma_f32 v[184:185], v[178:179], v[182:183], v[206:207] op_sel:[0,0,0] op_sel_hi:[0,1,1]
    v_pk_fma_f32 v[184:185], v[178:179], v[182:183], v[184:185] op_sel:[1,1,0] op_sel_hi:[1,0,1] neg_lo:[1,0,0]
    v_accvgpr_read_b32 v204, a4
    v_accvgpr_read_b32 v205, a5
    s_nop 0
    v_pk_fma_f32 v[182:183], v[178:179], v[184:185], v[204:205] op_sel:[0,0,0] op_sel_hi:[0,1,1]
    v_pk_fma_f32 v[182:183], v[178:179], v[184:185], v[182:183] op_sel:[1,1,0] op_sel_hi:[1,0,1] neg_lo:[1,0,0]
    v_accvgpr_read_b32 v206, a2
    v_accvgpr_read_b32 v207, a3
    s_nop 0
    v_pk_fma_f32 v[184:185], v[178:179], v[182:183], v[206:207] op_sel:[0,0,0] op_sel_hi:[0,1,1]
    v_pk_fma_f32 v[184:185], v[178:179], v[182:183], v[184:185] op_sel:[1,1,0] op_sel_hi:[1,0,1] neg_lo:[1,0,0]
    v_accvgpr_read_b32 v204, a0
    v_accvgpr_read_b32 v205, a1
    s_nop 0
    v_pk_fma_f32 v[182:183], v[178:179], v[184:185], v[204:205] op_sel:[0,0,0] op_sel_hi:[0,1,1]
    v_pk_fma_f32 v[182:183], v[178:179], v[184:185], v[182:183] op_sel:[1,1,0] op_sel_hi:[1,0,1] neg_lo:[1,0,0]
    v_cmp_u_f32 vcc, v182, v182
    s_add_u32 s88, s88, 1
    s_nop 3
    s_cmp_gt_u32 s88, 20000
    s_cbranch_scc1 L_back_e
    s_cmp_eq_u64 vcc, 0
    s_cbranch_scc1 L_back_e
    s_branch L_loop_e
L_slow_a:
    s_mov_b32 s88, 0
L_loop_a:
    buffer_load_dword v30, v31, s[56:59], 0 offen sc1
    s_waitcnt vmcnt(0)
    v_readlane_b32 s81, v30, 0
    s_nop 1
    s_add_u32 s88, s88, 1
    s_cmp_gt_u32 s88, 100000
    s_cbranch_scc1 L_back_a
    s_lshl_b32 s82, s40, 3
    s_lshr_b32 s81, s81, s82
    s_and_b32 s81, s81, 0xff
    s_cmp_eq_u32 s81, 4
    s_cbranch_scc1 L_back_a
    s_branch L_loop_a
L_exit:
    s_endpgm
L_codeend:
.section .rodata,"a"
.p2align 6
.amdhsa_kernel gated_mix__ssm_conv_s5__glu_gated_geglu__prompt_kernel
  .amdhsa_next_free_vgpr 512
  .amdhsa_next_free_sgpr 102
  .amdhsa_accum_offset 256
  .amdhsa_group_segment_fixed_size 0
  .amdhsa_kernarg_size 136
  .amdhsa_user_sgpr_count 2
  .amdhsa_user_sgpr_kernarg_segment_ptr 1
  .amdhsa_system_sgpr_workgroup_id_x 1
.end_amdhsa_kernel
```
